```python
import torch

def _softmax(x, axis=-1):
    return torch.softmax(x, dim=axis)
def _gelu(x):
    return torch.nn.functional.gelu(x, approximate="tanh")
def _silu(x):
    return torch.nn.functional.silu(x)
def _sigmoid(x):
    return torch.sigmoid(x)
def _layernorm(x, axis=-1, eps=1e-5):
    m = x.mean(dim=axis, keepdim=True)
    v = x.var(dim=axis, keepdim=True, unbiased=False)
    return (x - m) / torch.sqrt(v + eps)
def _scatter_add(tgt, idx, src, axis=0):
    return tgt.clone().index_add_(axis, idx, src)
def _segment_sum(src, seg, n):
    out = torch.zeros((n,) + src.shape[1:], dtype=src.dtype)
    return out.index_add_(0, seg, src)
def _pad(x, pw):
    flat = tuple(v for pair in reversed(pw) for v in pair)
    return torch.nn.functional.pad(x, flat)

kernel_name = 'gated_mix__spectral_gfnet__glu_gated_geglu__prompt'

def setup_inputs():

    _w = (lambda a: (lambda t: t.to(torch.bfloat16) if t.is_floating_point() else t)(torch.as_tensor(a)))
    def _A_setup():
        B, S, D = 1, 2048, 448
        Df = D // 2 + 1
        return {
            "x": _w((lambda *s: torch.randn(*s, dtype=torch.bfloat16) * 0.05)(B, S, D)),
            "w_r": _w((lambda *s: torch.randn(*s, dtype=torch.bfloat16) * 0.05)(S, Df) * 0.02),
            "w_i": _w((lambda *s: torch.randn(*s, dtype=torch.bfloat16) * 0.05)(S, Df) * 0.02),
        }
    _A_in = _A_setup()

    def _B_setup():
        B, S, Dm, Df = 1, 2048, 448, 1792
        return {
            "x": _w((lambda *s: torch.randn(*s, dtype=torch.bfloat16) * 0.05)(B, S, Dm)),
            "w_gate": _w((lambda *s: torch.randn(*s, dtype=torch.bfloat16) * 0.2)(Dm, Df) * (Dm ** -0.5)),
            "w_up": _w((lambda *s: torch.randn(*s, dtype=torch.bfloat16) * 0.2)(Dm, Df) * (Dm ** -0.5)),
            "w_down": _w((lambda *s: torch.randn(*s, dtype=torch.bfloat16) * 0.2)(Df, Dm) * (Df ** -0.5)),
        }
    _B_in = _B_setup()

    return {
        "A_x": _A_in["x"],
        "A_w_r": _A_in["w_r"],
        "A_w_i": _A_in["w_i"],
        "B_x": _B_in["x"],
        "B_w_gate": _B_in["w_gate"],
        "B_w_up": _B_in["w_up"],
        "B_w_down": _B_in["w_down"],
        "gate_w": _w((lambda *s: torch.randn(*s, dtype=torch.bfloat16) * 0.05)(448) * 16.0),
    }

def reference(A_x, A_w_r, A_w_i, B_x, B_w_gate, B_w_up, B_w_down, gate_w):
    def _A_ref(x, w_r, w_i):
        B, S, D = x.shape
        X = (lambda x, axes=(-2,-1): torch.fft.rfft2(x.float(), dim=axes))(x, axes=(-2, -1))
        W = w_r + 1j * w_i
        X = X * W
        y = (lambda x, s, axes=(-2,-1): torch.fft.irfft2(x, s=s, dim=axes).to(torch.bfloat16))(X, (S, D), axes=(-2, -1))
        return y

    def _B_ref(x, w_gate, w_up, w_down):
        g = torch.einsum("bsd,df->bsf", x, w_gate)
        u = torch.einsum("bsd,df->bsf", x, w_up)
        h = _gelu(g) * u
        return torch.einsum("bsf,fd->bsd", h, w_down)

    x = A_x
    g = _sigmoid((x * gate_w).sum(-1, keepdims=True))
    a = _A_ref(x, A_w_r, A_w_i)
    b = _B_ref(x, B_w_gate, B_w_up, B_w_down)
    return g * a + (1 - g) * b
```

```asm
; @launch kernel=k1_kernel grid=(256,1,1) block=(512,1,1) lds=155648
; @launch kernel=k2_kernel grid=(449,1,1) block=(256,1,1) lds=81920
.amdgcn_target "amdgcn-amd-amdhsa--gfx950"
.text
.globl k1_kernel
.p2align 8
.type k1_kernel,@function
k1_kernel:
  s_cmp_ge_u32 s2, 256
  s_cbranch_scc1 K1_END
  s_load_dwordx2 s[4:5], s[0:1], 0
  s_load_dwordx2 s[6:7], s[0:1], 32
  s_load_dwordx2 s[8:9], s[0:1], 40
  s_load_dwordx2 s[10:11], s[0:1], 8
  s_load_dwordx2 s[12:13], s[0:1], 16
  s_load_dwordx2 s[14:15], s[0:1], 56
  s_load_dwordx2 s[16:17], s[0:1], 80
  s_load_dwordx2 s[72:73], s[0:1], 48
  v_lshrrev_b32 v1, 6, v0
  s_nop 0
  v_readfirstlane_b32 s58, v1
  s_and_b32 s57, s2, 1
  s_lshl_b32 s57, s57, 2
  s_lshr_b32 s75, s2, 3
  s_and_b32 s61, s75, 3
  s_add_u32 s57, s57, s61
  s_bfe_u32 s74, s2, 0x20001
  s_lshr_b32 s62, s2, 5
  s_add_u32 s62, s62, 7
  s_and_b32 s62, s62, 7
  s_getpc_b64 s[18:19]
  s_add_u32 s18, s18, tblF@rel32@lo+4
  s_addc_u32 s19, s19, tblF@rel32@hi+12
  s_waitcnt lgkmcnt(0)
  s_mov_b32 s20, s4
  s_and_b32 s21, s5, 0xffff
  s_mov_b32 s22, 1835008
  s_mov_b32 s23, 0x00020000
  s_mov_b32 s36, s10
  s_and_b32 s37, s11, 0xffff
  s_mov_b32 s38, 921600
  s_mov_b32 s39, 0x00020000
  s_mov_b32 s40, s12
  s_and_b32 s41, s13, 0xffff
  s_mov_b32 s42, 921600
  s_mov_b32 s43, 0x00020000
  s_mov_b32 s48, s14
  s_and_b32 s49, s15, 0xffff
  s_mov_b32 s50, 896
  s_mov_b32 s51, 0x00020000
  s_add_u32 s44, s16, 12582912
  s_addc_u32 s45, s17, 0
  s_and_b32 s45, s45, 0xffff
  s_mov_b32 s46, 1843200
  s_mov_b32 s47, 0x00020000
  s_add_u32 s52, s16, 14680064
  s_addc_u32 s53, s17, 0
  s_and_b32 s53, s53, 0xffff
  s_mov_b32 s54, 5246976
  s_mov_b32 s55, 0x00020000
  s_getpc_b64 s[28:29]
  s_add_u32 s28, s28, tblG@rel32@lo+4
  s_addc_u32 s29, s29, tblG@rel32@hi+12
  s_mov_b32 s88, s72
  s_mov_b32 s89, s73
  s_mov_b32 s90, 1605632
  s_mov_b32 s66, 6272
  s_cmp_eq_u32 s58, 1
  s_cselect_b32 s88, s28, s88
  s_cselect_b32 s89, s29, s89
  s_cselect_b32 s90, 403968, s90
  s_cselect_b32 s66, 1578, s66
  s_cmp_ge_u32 s58, 2
  s_cselect_b32 s88, s4, s88
  s_cselect_b32 s89, s5, s89
  s_cselect_b32 s90, 0, s90
  s_cselect_b32 s66, 0, s66
  s_and_b32 s89, s89, 0xffff
  s_mov_b32 s91, 0x00020000
  v_and_b32 v1, 63, v0
  v_lshlrev_b32 v30, 7, v1
  v_mov_b32 v3, 0x7f000000
  v_cmp_gt_u32 vcc, s66, v30
  s_mul_i32 s87, s66, s2
  s_and_b32 s87, s87, 0xfffffffc
  v_cndmask_b32 v30, v3, v30, vcc
  s_cmp_ge_u32 s62, 7
  s_cselect_b32 s63, 1, 0
  s_cbranch_scc1 K1_SETUP_DFT
  s_mul_i32 s56, s74, 7
  s_add_u32 s56, s56, s62
  s_lshl_b32 s61, s56, 7
  s_add_u32 s24, s6, s61
  s_addc_u32 s25, s7, 0
  s_and_b32 s25, s25, 0xffff
  s_sub_u32 s26, 1605632, s61
  s_mov_b32 s27, 0x00020000
  s_add_u32 s28, s8, s61
  s_addc_u32 s29, s9, 0
  s_and_b32 s29, s29, 0xffff
  s_sub_u32 s30, 1605632, s61
  s_mov_b32 s31, 0x00020000
  s_mov_b32 s59, 3584
  s_add_u32 s32, s16, 0
  s_addc_u32 s33, s17, 0
  s_and_b32 s33, s33, 0xffff
  s_mov_b32 s34, 7340032
  s_mov_b32 s35, 0x00020000
  s_branch K1_SETUP_DONE
K1_SETUP_DFT:
  s_mov_b32 s56, s74
  s_lshl_b32 s61, s56, 8
  s_add_u32 s24, s18, s61
  s_addc_u32 s25, s19, 0
  s_and_b32 s25, s25, 0xffff
  s_sub_u32 s26, 458752, s61
  s_mov_b32 s27, 0x00020000
  s_add_u32 s61, s61, 128
  s_add_u32 s28, s18, s61
  s_addc_u32 s29, s19, 0
  s_and_b32 s29, s29, 0xffff
  s_sub_u32 s30, 458752, s61
  s_mov_b32 s31, 0x00020000
  s_mov_b32 s59, 1024
  s_add_u32 s32, s16, 8388608
  s_addc_u32 s33, s17, 0
  s_and_b32 s33, s33, 0xffff
  s_mov_b32 s34, 3670016
  s_mov_b32 s35, 0x00020000
K1_SETUP_DONE:
  s_mov_b32 s4, s88
  s_mov_b32 s5, s89
  s_mov_b32 s6, s90
  s_mov_b32 s7, 0x00020000
  s_mov_b32 s8, s87
  v_and_b32 v1, 63, v0
  v_lshrrev_b32 v13, 3, v1
  s_lshl_b32 s61, s57, 8
  s_lshl_b32 s62, s58, 5
  s_add_u32 s61, s61, s62
  v_add_u32 v13, s61, v13
  v_mul_u32_u24 v13, 896, v13
  v_lshrrev_b32 v14, 4, v1
  v_and_b32 v15, 7, v1
  v_xor_b32 v15, v15, v14
  v_xor_b32 v14, 4, v15
  v_lshl_add_u32 v2, v15, 4, v13
  v_lshl_add_u32 v3, v14, 4, v13
  v_add_u32 v3, 7168, v3
  v_lshl_add_u32 v4, v15, 4, v13
  v_add_u32 v4, 14336, v4
  v_lshl_add_u32 v5, v14, 4, v13
  v_add_u32 v5, 21504, v5
  v_lshrrev_b32 v13, 3, v1
  s_lshl_b32 s61, s58, 3
  v_add_u32 v13, s61, v13
  v_mul_lo_u32 v13, v13, s59
  v_bfe_u32 v14, v1, 4, 1
  s_and_b32 s62, s58, 1
  s_lshl_b32 s62, s62, 1
  v_or_b32 v14, s62, v14
  v_bfe_u32 v15, v1, 1, 2
  v_xor_b32 v15, v15, v14
  v_lshl_add_u32 v13, v15, 5, v13
  v_and_b32 v15, 1, v1
  v_lshl_add_u32 v6, v15, 4, v13
  s_lshl_b32 s64, s58, 12
  s_lshl_b32 s65, s58, 10
  s_add_u32 s65, s65, 98304
  s_mov_b32 s66, 0
  s_mul_i32 s67, s59, 0
  s_add_u32 m0, s64, 0
  s_nop 0
  buffer_load_dwordx4 v2, s[20:23], s66 offen lds
  s_add_u32 m0, s64, 1024
  s_nop 0
  buffer_load_dwordx4 v3, s[20:23], s66 offen lds
  s_add_u32 m0, s64, 2048
  s_nop 0
  buffer_load_dwordx4 v4, s[20:23], s66 offen lds
  s_add_u32 m0, s64, 3072
  s_nop 0
  buffer_load_dwordx4 v5, s[20:23], s66 offen lds
  s_add_u32 m0, s65, 0
  s_nop 0
  buffer_load_dwordx4 v6, s[24:27], s67 offen lds
  s_add_u32 m0, s65, 8192
  s_nop 0
  buffer_load_dwordx4 v6, s[28:31], s67 offen lds
  s_barrier
  s_mov_b32 s66, 128
  s_mul_i32 s67, s59, 64
  s_add_u32 m0, s64, 32768
  s_nop 0
  buffer_load_dwordx4 v2, s[20:23], s66 offen lds
  s_add_u32 m0, s64, 33792
  s_nop 0
  buffer_load_dwordx4 v3, s[20:23], s66 offen lds
  s_add_u32 m0, s64, 34816
  s_nop 0
  buffer_load_dwordx4 v4, s[20:23], s66 offen lds
  s_add_u32 m0, s64, 35840
  s_nop 0
  buffer_load_dwordx4 v5, s[20:23], s66 offen lds
  s_add_u32 m0, s65, 16384
  s_nop 0
  buffer_load_dwordx4 v6, s[24:27], s67 offen lds
  s_add_u32 m0, s65, 24576
  s_nop 0
  buffer_load_dwordx4 v6, s[28:31], s67 offen lds
  v_and_b32 v14, 31, v0
  v_lshlrev_b32 v14, 7, v14
  v_lshrrev_b32 v15, 5, v0
  v_lshl_add_u32 v14, v15, 2, v14
  v_add_u32 v14, 5242880, v14
  v_mov_b32 v15, 0x7f000000
  v_cmp_gt_u32 vcc, 256, v0
  s_cmp_eq_u32 s2, 0
  s_cselect_b32 s61, 0, 0x7f000000
  v_cndmask_b32 v14, v15, v14, vcc
  v_cmp_le_u32 vcc, 225, v0
  s_nop 1
  v_cndmask_b32 v15, 0, 1, vcc
  buffer_store_dword v15, v14, s[52:55], s61 offen
  s_lshl_b32 s60, s2, 3
  s_add_u32 s60, s60, s58
  s_mul_i32 s62, s60, 896
  v_lshlrev_b32 v14, 4, v1
  v_mov_b32 v15, 0x7f000000
  v_cmp_gt_u32 vcc, 56, v1
  s_nop 1
  v_cndmask_b32 v15, v15, v14, vcc
  buffer_load_dwordx4 v[192:195], v15, s[20:23], s62 offen
  buffer_load_dwordx4 v[196:199], v14, s[48:51], 0 offen
  s_lshl_b32 s61, s60, 2
  v_mov_b32 v20, 0x7f000000
  v_mov_b32 v14, s61
  v_cmp_eq_u32 vcc, 63, v1
  s_nop 1
  v_cndmask_b32 v20, v20, v14, vcc
  v_and_b32 v13, 15, v1
  s_lshr_b32 s61, s58, 1
  s_lshl_b32 s61, s61, 6
  v_add_u32 v14, s61, v13
  v_lshlrev_b32 v14, 7, v14
  v_lshrrev_b32 v13, 1, v13
  v_lshrrev_b32 v15, 4, v1
  v_xor_b32 v13, v13, v15
  v_lshl_add_u32 v7, v13, 4, v14
  v_xor_b32 v8, 64, v7
  v_add_u32 v9, 0x10000, v7
  v_add_u32 v10, 0x10000, v8
  v_bfe_u32 v13, v1, 2, 2
  v_lshl_add_u32 v14, v15, 3, v13
  v_lshlrev_b32 v14, 7, v14
  v_add_u32 v14, 98304, v14
  v_and_b32 v18, 3, v1
  v_lshl_add_u32 v14, v18, 3, v14
  v_lshrrev_b32 v13, 1, v13
  v_and_b32 v15, 1, v15
  v_lshl_or_b32 v13, v15, 1, v13
  s_and_b32 s61, s58, 1
  s_lshl_b32 s61, s61, 1
  v_xor_b32 v13, s61, v13
  v_lshl_add_u32 v11, v13, 5, v14
  v_xor_b32 v12, 32, v11
  v_mov_b32 v64, 0
  v_mov_b32 v65, 0
  v_mov_b32 v66, 0
  v_mov_b32 v67, 0
  v_mov_b32 v68, 0
  v_mov_b32 v69, 0
  v_mov_b32 v70, 0
  v_mov_b32 v71, 0
  v_mov_b32 v72, 0
  v_mov_b32 v73, 0
  v_mov_b32 v74, 0
  v_mov_b32 v75, 0
  v_mov_b32 v76, 0
  v_mov_b32 v77, 0
  v_mov_b32 v78, 0
  v_mov_b32 v79, 0
  v_mov_b32 v80, 0
  v_mov_b32 v81, 0
  v_mov_b32 v82, 0
  v_mov_b32 v83, 0
  v_mov_b32 v84, 0
  v_mov_b32 v85, 0
  v_mov_b32 v86, 0
  v_mov_b32 v87, 0
  v_mov_b32 v88, 0
  v_mov_b32 v89, 0
  v_mov_b32 v90, 0
  v_mov_b32 v91, 0
  v_mov_b32 v92, 0
  v_mov_b32 v93, 0
  v_mov_b32 v94, 0
  v_mov_b32 v95, 0
  v_mov_b32 v96, 0
  v_mov_b32 v97, 0
  v_mov_b32 v98, 0
  v_mov_b32 v99, 0
  v_mov_b32 v100, 0
  v_mov_b32 v101, 0
  v_mov_b32 v102, 0
  v_mov_b32 v103, 0
  v_mov_b32 v104, 0
  v_mov_b32 v105, 0
  v_mov_b32 v106, 0
  v_mov_b32 v107, 0
  v_mov_b32 v108, 0
  v_mov_b32 v109, 0
  v_mov_b32 v110, 0
  v_mov_b32 v111, 0
  v_mov_b32 v112, 0
  v_mov_b32 v113, 0
  v_mov_b32 v114, 0
  v_mov_b32 v115, 0
  v_mov_b32 v116, 0
  v_mov_b32 v117, 0
  v_mov_b32 v118, 0
  v_mov_b32 v119, 0
  v_mov_b32 v120, 0
  v_mov_b32 v121, 0
  v_mov_b32 v122, 0
  v_mov_b32 v123, 0
  v_mov_b32 v124, 0
  v_mov_b32 v125, 0
  v_mov_b32 v126, 0
  v_mov_b32 v127, 0
  s_cmp_eq_u32 s63, 1
  s_cbranch_scc1 K1_DFT
  s_waitcnt vmcnt(9)
  s_barrier
  s_mov_b32 s66, 256
  s_mul_i32 s67, s59, 128
  s_add_u32 m0, s64, 65536
  s_nop 0
  buffer_load_dwordx4 v2, s[20:23], s66 offen lds
  s_add_u32 m0, s64, 66560
  s_nop 0
  buffer_load_dwordx4 v3, s[20:23], s66 offen lds
  s_add_u32 m0, s64, 67584
  s_nop 0
  buffer_load_dwordx4 v4, s[20:23], s66 offen lds
  s_add_u32 m0, s64, 68608
  s_nop 0
  buffer_load_dwordx4 v5, s[20:23], s66 offen lds
  s_add_u32 m0, s65, 32768
  s_nop 0
  buffer_load_dwordx4 v6, s[24:27], s67 offen lds
  s_add_u32 m0, s65, 40960
  s_nop 0
  buffer_load_dwordx4 v6, s[28:31], s67 offen lds
  ds_read_b128 v[128:131], v7 offset:0
  ds_read_b128 v[132:135], v7 offset:2048
  ds_read_b128 v[136:139], v7 offset:4096
  ds_read_b128 v[140:143], v7 offset:6144
  ds_read_b64_tr_b16 v[160:161], v11 offset:0
  ds_read_b64_tr_b16 v[162:163], v11 offset:512
  ds_read_b64_tr_b16 v[164:165], v12 offset:0
  ds_read_b64_tr_b16 v[166:167], v12 offset:512
  ds_read_b64_tr_b16 v[168:169], v11 offset:8192
  ds_read_b64_tr_b16 v[170:171], v11 offset:8704
  ds_read_b64_tr_b16 v[172:173], v12 offset:8192
  ds_read_b64_tr_b16 v[174:175], v12 offset:8704
  ds_read_b128 v[144:147], v8 offset:0
  ds_read_b128 v[148:151], v8 offset:2048
  ds_read_b128 v[152:155], v8 offset:4096
  ds_read_b128 v[156:159], v8 offset:6144
  s_waitcnt lgkmcnt(4)
  ds_read_b64_tr_b16 v[176:177], v11 offset:4096
  ds_read_b64_tr_b16 v[178:179], v11 offset:4608
  v_mfma_f32_16x16x32_bf16 v[64:67], v[160:163], v[128:131], v[64:67]
  v_mfma_f32_16x16x32_bf16 v[68:71], v[160:163], v[132:135], v[68:71]
  v_mfma_f32_16x16x32_bf16 v[72:75], v[160:163], v[136:139], v[72:75]
  v_mfma_f32_16x16x32_bf16 v[76:79], v[160:163], v[140:143], v[76:79]
  ds_read_b64_tr_b16 v[180:181], v12 offset:4096
  ds_read_b64_tr_b16 v[182:183], v12 offset:4608
  v_mfma_f32_16x16x32_bf16 v[80:83], v[164:167], v[128:131], v[80:83]
  v_mfma_f32_16x16x32_bf16 v[84:87], v[164:167], v[132:135], v[84:87]
  v_mfma_f32_16x16x32_bf16 v[88:91], v[164:167], v[136:139], v[88:91]
  v_mfma_f32_16x16x32_bf16 v[92:95], v[164:167], v[140:143], v[92:95]
  ds_read_b64_tr_b16 v[184:185], v11 offset:12288
  ds_read_b64_tr_b16 v[186:187], v11 offset:12800
  v_mfma_f32_16x16x32_bf16 v[96:99], v[168:171], v[128:131], v[96:99]
  v_mfma_f32_16x16x32_bf16 v[100:103], v[168:171], v[132:135], v[100:103]
  v_mfma_f32_16x16x32_bf16 v[104:107], v[168:171], v[136:139], v[104:107]
  v_mfma_f32_16x16x32_bf16 v[108:111], v[168:171], v[140:143], v[108:111]
  ds_read_b64_tr_b16 v[188:189], v12 offset:12288
  ds_read_b64_tr_b16 v[190:191], v12 offset:12800
  v_mfma_f32_16x16x32_bf16 v[112:115], v[172:175], v[128:131], v[112:115]
  v_mfma_f32_16x16x32_bf16 v[116:119], v[172:175], v[132:135], v[116:119]
  v_mfma_f32_16x16x32_bf16 v[120:123], v[172:175], v[136:139], v[120:123]
  v_mfma_f32_16x16x32_bf16 v[124:127], v[172:175], v[140:143], v[124:127]
  s_waitcnt vmcnt(9) lgkmcnt(0)
  s_barrier
  s_mov_b32 s66, 384
  s_mul_i32 s67, s59, 192
  ds_read_b128 v[128:131], v7 offset:32768
  ds_read_b64_tr_b16 v[160:161], v11 offset:16384
  ds_read_b64_tr_b16 v[162:163], v11 offset:16896
  v_mfma_f32_16x16x32_bf16 v[64:67], v[176:179], v[144:147], v[64:67]
  s_add_u32 m0, s64, 0
  s_nop 0
  buffer_load_dwordx4 v2, s[20:23], s66 offen lds
  v_mfma_f32_16x16x32_bf16 v[68:71], v[176:179], v[148:151], v[68:71]
  v_mfma_f32_16x16x32_bf16 v[72:75], v[176:179], v[152:155], v[72:75]
  v_mfma_f32_16x16x32_bf16 v[76:79], v[176:179], v[156:159], v[76:79]
  s_add_u32 m0, s64, 1024
  s_nop 0
  buffer_load_dwordx4 v3, s[20:23], s66 offen lds
  ds_read_b128 v[132:135], v7 offset:34816
  ds_read_b64_tr_b16 v[164:165], v12 offset:16384
  ds_read_b64_tr_b16 v[166:167], v12 offset:16896
  v_mfma_f32_16x16x32_bf16 v[80:83], v[180:183], v[144:147], v[80:83]
  v_mfma_f32_16x16x32_bf16 v[84:87], v[180:183], v[148:151], v[84:87]
  s_add_u32 m0, s64, 2048
  s_nop 0
  buffer_load_dwordx4 v4, s[20:23], s66 offen lds
  v_mfma_f32_16x16x32_bf16 v[88:91], v[180:183], v[152:155], v[88:91]
  v_mfma_f32_16x16x32_bf16 v[92:95], v[180:183], v[156:159], v[92:95]
  ds_read_b128 v[136:139], v7 offset:36864
  ds_read_b64_tr_b16 v[168:169], v11 offset:24576
  ds_read_b64_tr_b16 v[170:171], v11 offset:25088
  v_mfma_f32_16x16x32_bf16 v[96:99], v[184:187], v[144:147], v[96:99]
  s_add_u32 m0, s64, 3072
  s_nop 0
  buffer_load_dwordx4 v5, s[20:23], s66 offen lds
  v_mfma_f32_16x16x32_bf16 v[100:103], v[184:187], v[148:151], v[100:103]
  v_mfma_f32_16x16x32_bf16 v[104:107], v[184:187], v[152:155], v[104:107]
  s_add_u32 m0, s65, 0
  s_nop 0
  buffer_load_dwordx4 v6, s[24:27], s67 offen lds
  v_mfma_f32_16x16x32_bf16 v[108:111], v[184:187], v[156:159], v[108:111]
  ds_read_b128 v[140:143], v7 offset:38912
  ds_read_b64_tr_b16 v[172:173], v12 offset:24576
  ds_read_b64_tr_b16 v[174:175], v12 offset:25088
  v_mfma_f32_16x16x32_bf16 v[112:115], v[188:191], v[144:147], v[112:115]
  v_mfma_f32_16x16x32_bf16 v[116:119], v[188:191], v[148:151], v[116:119]
  s_add_u32 m0, s65, 8192
  s_nop 0
  buffer_load_dwordx4 v6, s[28:31], s67 offen lds
  v_mfma_f32_16x16x32_bf16 v[120:123], v[188:191], v[152:155], v[120:123]
  v_mfma_f32_16x16x32_bf16 v[124:127], v[188:191], v[156:159], v[124:127]
  ds_read_b128 v[144:147], v8 offset:32768
  ds_read_b128 v[148:151], v8 offset:34816
  ds_read_b128 v[152:155], v8 offset:36864
  ds_read_b128 v[156:159], v8 offset:38912
  s_waitcnt lgkmcnt(4)
  ds_read_b64_tr_b16 v[176:177], v11 offset:20480
  ds_read_b64_tr_b16 v[178:179], v11 offset:20992
  v_mfma_f32_16x16x32_bf16 v[64:67], v[160:163], v[128:131], v[64:67]
  v_mfma_f32_16x16x32_bf16 v[68:71], v[160:163], v[132:135], v[68:71]
  v_mfma_f32_16x16x32_bf16 v[72:75], v[160:163], v[136:139], v[72:75]
  v_mfma_f32_16x16x32_bf16 v[76:79], v[160:163], v[140:143], v[76:79]
  ds_read_b64_tr_b16 v[180:181], v12 offset:20480
  ds_read_b64_tr_b16 v[182:183], v12 offset:20992
  v_mfma_f32_16x16x32_bf16 v[80:83], v[164:167], v[128:131], v[80:83]
  v_mfma_f32_16x16x32_bf16 v[84:87], v[164:167], v[132:135], v[84:87]
  v_mfma_f32_16x16x32_bf16 v[88:91], v[164:167], v[136:139], v[88:91]
  v_mfma_f32_16x16x32_bf16 v[92:95], v[164:167], v[140:143], v[92:95]
  ds_read_b64_tr_b16 v[184:185], v11 offset:28672
  ds_read_b64_tr_b16 v[186:187], v11 offset:29184
  v_mfma_f32_16x16x32_bf16 v[96:99], v[168:171], v[128:131], v[96:99]
  v_mfma_f32_16x16x32_bf16 v[100:103], v[168:171], v[132:135], v[100:103]
  v_mfma_f32_16x16x32_bf16 v[104:107], v[168:171], v[136:139], v[104:107]
  v_mfma_f32_16x16x32_bf16 v[108:111], v[168:171], v[140:143], v[108:111]
  ds_read_b64_tr_b16 v[188:189], v12 offset:28672
  ds_read_b64_tr_b16 v[190:191], v12 offset:29184
  v_mfma_f32_16x16x32_bf16 v[112:115], v[172:175], v[128:131], v[112:115]
  v_mfma_f32_16x16x32_bf16 v[116:119], v[172:175], v[132:135], v[116:119]
  v_mfma_f32_16x16x32_bf16 v[120:123], v[172:175], v[136:139], v[120:123]
  v_mfma_f32_16x16x32_bf16 v[124:127], v[172:175], v[140:143], v[124:127]
  s_waitcnt vmcnt(6) lgkmcnt(0)
  s_barrier
  s_mov_b32 s66, 512
  s_mul_i32 s67, s59, 256
  ds_read_b128 v[128:131], v9 offset:0
  ds_read_b64_tr_b16 v[160:161], v11 offset:32768
  ds_read_b64_tr_b16 v[162:163], v11 offset:33280
  v_mfma_f32_16x16x32_bf16 v[64:67], v[176:179], v[144:147], v[64:67]
  s_add_u32 m0, s64, 32768
  s_nop 0
  buffer_load_dwordx4 v2, s[20:23], s66 offen lds
  v_mfma_f32_16x16x32_bf16 v[68:71], v[176:179], v[148:151], v[68:71]
  v_lshlrev_b32 v200, 16, v196
  v_and_b32 v201, 0xffff0000, v196
  v_mfma_f32_16x16x32_bf16 v[72:75], v[176:179], v[152:155], v[72:75]
  v_lshlrev_b32 v208, 16, v192
  v_and_b32 v209, 0xffff0000, v192
  v_mfma_f32_16x16x32_bf16 v[76:79], v[176:179], v[156:159], v[76:79]
  s_add_u32 m0, s64, 33792
  s_nop 0
  buffer_load_dwordx4 v3, s[20:23], s66 offen lds
  ds_read_b128 v[132:135], v9 offset:2048
  ds_read_b64_tr_b16 v[164:165], v12 offset:32768
  ds_read_b64_tr_b16 v[166:167], v12 offset:33280
  v_mfma_f32_16x16x32_bf16 v[80:83], v[180:183], v[144:147], v[80:83]
  v_lshlrev_b32 v202, 16, v197
  v_and_b32 v203, 0xffff0000, v197
  v_mfma_f32_16x16x32_bf16 v[84:87], v[180:183], v[148:151], v[84:87]
  s_add_u32 m0, s64, 34816
  s_nop 0
  buffer_load_dwordx4 v4, s[20:23], s66 offen lds
  v_mfma_f32_16x16x32_bf16 v[88:91], v[180:183], v[152:155], v[88:91]
  v_lshlrev_b32 v210, 16, v193
  v_and_b32 v211, 0xffff0000, v193
  v_mfma_f32_16x16x32_bf16 v[92:95], v[180:183], v[156:159], v[92:95]
  v_lshlrev_b32 v204, 16, v198
  v_and_b32 v205, 0xffff0000, v198
  ds_read_b128 v[136:139], v9 offset:4096
  ds_read_b64_tr_b16 v[168:169], v11 offset:40960
  ds_read_b64_tr_b16 v[170:171], v11 offset:41472
  v_mfma_f32_16x16x32_bf16 v[96:99], v[184:187], v[144:147], v[96:99]
  s_add_u32 m0, s64, 35840
  s_nop 0
  buffer_load_dwordx4 v5, s[20:23], s66 offen lds
  v_mfma_f32_16x16x32_bf16 v[100:103], v[184:187], v[148:151], v[100:103]
  v_lshlrev_b32 v212, 16, v194
  v_and_b32 v213, 0xffff0000, v194
  v_mfma_f32_16x16x32_bf16 v[104:107], v[184:187], v[152:155], v[104:107]
  s_add_u32 m0, s65, 16384
  s_nop 0
  buffer_load_dwordx4 v6, s[24:27], s67 offen lds
  v_mfma_f32_16x16x32_bf16 v[108:111], v[184:187], v[156:159], v[108:111]
  v_lshlrev_b32 v206, 16, v199
  v_and_b32 v207, 0xffff0000, v199
  ds_read_b128 v[140:143], v9 offset:6144
  ds_read_b64_tr_b16 v[172:173], v12 offset:40960
  ds_read_b64_tr_b16 v[174:175], v12 offset:41472
  v_mfma_f32_16x16x32_bf16 v[112:115], v[188:191], v[144:147], v[112:115]
  v_lshlrev_b32 v214, 16, v195
  v_and_b32 v215, 0xffff0000, v195
  v_mfma_f32_16x16x32_bf16 v[116:119], v[188:191], v[148:151], v[116:119]
  s_add_u32 m0, s65, 24576
  s_nop 0
  buffer_load_dwordx4 v6, s[28:31], s67 offen lds
  v_mfma_f32_16x16x32_bf16 v[120:123], v[188:191], v[152:155], v[120:123]
  v_pk_mul_f32 v[208:209], v[208:209], v[200:201]
  v_pk_mul_f32 v[210:211], v[210:211], v[202:203]
  v_mfma_f32_16x16x32_bf16 v[124:127], v[188:191], v[156:159], v[124:127]
  v_pk_mul_f32 v[212:213], v[212:213], v[204:205]
  v_pk_mul_f32 v[214:215], v[214:215], v[206:207]
  ds_read_b128 v[144:147], v10 offset:0
  ds_read_b128 v[148:151], v10 offset:2048
  ds_read_b128 v[152:155], v10 offset:4096
  ds_read_b128 v[156:159], v10 offset:6144
  s_waitcnt lgkmcnt(4)
  ds_read_b64_tr_b16 v[176:177], v11 offset:36864
  ds_read_b64_tr_b16 v[178:179], v11 offset:37376
  v_mfma_f32_16x16x32_bf16 v[64:67], v[160:163], v[128:131], v[64:67]
  v_cvt_pk_bf16_f32 v216, v208, v209
  v_lshlrev_b32 v208, 16, v216
  v_mfma_f32_16x16x32_bf16 v[68:71], v[160:163], v[132:135], v[68:71]
  v_and_b32 v209, 0xffff0000, v216
  v_cvt_pk_bf16_f32 v217, v210, v211
  v_mfma_f32_16x16x32_bf16 v[72:75], v[160:163], v[136:139], v[72:75]
  v_lshlrev_b32 v210, 16, v217
  v_and_b32 v211, 0xffff0000, v217
  v_mfma_f32_16x16x32_bf16 v[76:79], v[160:163], v[140:143], v[76:79]
  v_cvt_pk_bf16_f32 v218, v212, v213
  v_lshlrev_b32 v212, 16, v218
  ds_read_b64_tr_b16 v[180:181], v12 offset:36864
  ds_read_b64_tr_b16 v[182:183], v12 offset:37376
  v_mfma_f32_16x16x32_bf16 v[80:83], v[164:167], v[128:131], v[80:83]
  v_and_b32 v213, 0xffff0000, v218
  v_cvt_pk_bf16_f32 v219, v214, v215
  v_mfma_f32_16x16x32_bf16 v[84:87], v[164:167], v[132:135], v[84:87]
  v_lshlrev_b32 v214, 16, v219
  v_and_b32 v215, 0xffff0000, v219
  v_mfma_f32_16x16x32_bf16 v[88:91], v[164:167], v[136:139], v[88:91]
  v_pk_add_f32 v[208:209], v[208:209], v[210:211]
  v_pk_add_f32 v[212:213], v[212:213], v[214:215]
  v_mfma_f32_16x16x32_bf16 v[92:95], v[164:167], v[140:143], v[92:95]
  v_pk_add_f32 v[208:209], v[208:209], v[212:213]
  v_add_f32 v208, v208, v209
  ds_read_b64_tr_b16 v[184:185], v11 offset:45056
  ds_read_b64_tr_b16 v[186:187], v11 offset:45568
  v_mfma_f32_16x16x32_bf16 v[96:99], v[168:171], v[128:131], v[96:99]
  s_nop 1
  v_add_f32_dpp v208, v208, v208 row_shr:1 row_mask:0xf bank_mask:0xf bound_ctrl:0
  v_mfma_f32_16x16x32_bf16 v[100:103], v[168:171], v[132:135], v[100:103]
  s_nop 1
  v_add_f32_dpp v208, v208, v208 row_shr:2 row_mask:0xf bank_mask:0xf bound_ctrl:0
  v_mfma_f32_16x16x32_bf16 v[104:107], v[168:171], v[136:139], v[104:107]
  s_nop 1
  v_add_f32_dpp v208, v208, v208 row_shr:4 row_mask:0xf bank_mask:0xf bound_ctrl:0
  v_mfma_f32_16x16x32_bf16 v[108:111], v[168:171], v[140:143], v[108:111]
  s_nop 1
  v_add_f32_dpp v208, v208, v208 row_shr:8 row_mask:0xf bank_mask:0xf bound_ctrl:0
  ds_read_b64_tr_b16 v[188:189], v12 offset:45056
  ds_read_b64_tr_b16 v[190:191], v12 offset:45568
  v_mfma_f32_16x16x32_bf16 v[112:115], v[172:175], v[128:131], v[112:115]
  s_nop 1
  v_add_f32_dpp v208, v208, v208 row_bcast:15 row_mask:0xa bank_mask:0xf
  v_mfma_f32_16x16x32_bf16 v[116:119], v[172:175], v[132:135], v[116:119]
  s_nop 1
  v_add_f32_dpp v208, v208, v208 row_bcast:31 row_mask:0xc bank_mask:0xf
  v_mfma_f32_16x16x32_bf16 v[120:123], v[172:175], v[136:139], v[120:123]
  v_cvt_pk_bf16_f32 v208, v208, v208
  v_lshlrev_b32 v208, 16, v208
  v_mfma_f32_16x16x32_bf16 v[124:127], v[172:175], v[140:143], v[124:127]
  v_mul_f32 v208, 0xbfb8aa3b, v208
  v_exp_f32 v208, v208
  s_waitcnt vmcnt(6) lgkmcnt(0)
  s_barrier
  s_mov_b32 s66, 640
  s_mul_i32 s67, s59, 320
  ds_read_b128 v[128:131], v7 offset:0
  ds_read_b64_tr_b16 v[160:161], v11 offset:0
  ds_read_b64_tr_b16 v[162:163], v11 offset:512
  v_mfma_f32_16x16x32_bf16 v[64:67], v[176:179], v[144:147], v[64:67]
  s_add_u32 m0, s64, 65536
  s_nop 0
  buffer_load_dwordx4 v2, s[20:23], s66 offen lds
  v_mfma_f32_16x16x32_bf16 v[68:71], v[176:179], v[148:151], v[68:71]
  s_nop 0
  v_add_f32 v208, 1.0, v208
  v_mfma_f32_16x16x32_bf16 v[72:75], v[176:179], v[152:155], v[72:75]
  v_rcp_f32 v208, v208
  s_nop 0
  v_mfma_f32_16x16x32_bf16 v[76:79], v[176:179], v[156:159], v[76:79]
  s_add_u32 m0, s64, 66560
  s_nop 0
  buffer_load_dwordx4 v3, s[20:23], s66 offen lds
  ds_read_b128 v[132:135], v7 offset:2048
  ds_read_b64_tr_b16 v[164:165], v12 offset:0
  ds_read_b64_tr_b16 v[166:167], v12 offset:512
  v_mfma_f32_16x16x32_bf16 v[80:83], v[180:183], v[144:147], v[80:83]
  v_cvt_pk_bf16_f32 v208, v208, v208
  v_lshlrev_b32 v208, 16, v208
  v_mfma_f32_16x16x32_bf16 v[84:87], v[180:183], v[148:151], v[84:87]
  s_add_u32 m0, s64, 67584
  s_nop 0
  buffer_load_dwordx4 v4, s[20:23], s66 offen lds
  v_mfma_f32_16x16x32_bf16 v[88:91], v[180:183], v[152:155], v[88:91]
  buffer_store_dword v208, v20, s[52:55], 0 offen
  v_mfma_f32_16x16x32_bf16 v[92:95], v[180:183], v[156:159], v[92:95]
  ds_read_b128 v[136:139], v7 offset:4096
  ds_read_b64_tr_b16 v[168:169], v11 offset:8192
  ds_read_b64_tr_b16 v[170:171], v11 offset:8704
  v_mfma_f32_16x16x32_bf16 v[96:99], v[184:187], v[144:147], v[96:99]
  s_add_u32 m0, s64, 68608
  s_nop 0
  buffer_load_dwordx4 v5, s[20:23], s66 offen lds
  v_mfma_f32_16x16x32_bf16 v[100:103], v[184:187], v[148:151], v[100:103]
  v_mfma_f32_16x16x32_bf16 v[104:107], v[184:187], v[152:155], v[104:107]
  s_add_u32 m0, s65, 32768
  s_nop 0
  buffer_load_dwordx4 v6, s[24:27], s67 offen lds
  v_mfma_f32_16x16x32_bf16 v[108:111], v[184:187], v[156:159], v[108:111]
  ds_read_b128 v[140:143], v7 offset:6144
  ds_read_b64_tr_b16 v[172:173], v12 offset:8192
  ds_read_b64_tr_b16 v[174:175], v12 offset:8704
  v_mfma_f32_16x16x32_bf16 v[112:115], v[188:191], v[144:147], v[112:115]
  v_mfma_f32_16x16x32_bf16 v[116:119], v[188:191], v[148:151], v[116:119]
  s_add_u32 m0, s65, 40960
  s_nop 0
  buffer_load_dwordx4 v6, s[28:31], s67 offen lds
  v_mfma_f32_16x16x32_bf16 v[120:123], v[188:191], v[152:155], v[120:123]
  v_mfma_f32_16x16x32_bf16 v[124:127], v[188:191], v[156:159], v[124:127]
  ds_read_b128 v[144:147], v8 offset:0
  ds_read_b128 v[148:151], v8 offset:2048
  ds_read_b128 v[152:155], v8 offset:4096
  ds_read_b128 v[156:159], v8 offset:6144
  s_waitcnt lgkmcnt(4)
  ds_read_b64_tr_b16 v[176:177], v11 offset:4096
  ds_read_b64_tr_b16 v[178:179], v11 offset:4608
  v_mfma_f32_16x16x32_bf16 v[64:67], v[160:163], v[128:131], v[64:67]
  v_mfma_f32_16x16x32_bf16 v[68:71], v[160:163], v[132:135], v[68:71]
  v_mfma_f32_16x16x32_bf16 v[72:75], v[160:163], v[136:139], v[72:75]
  v_mfma_f32_16x16x32_bf16 v[76:79], v[160:163], v[140:143], v[76:79]
  ds_read_b64_tr_b16 v[180:181], v12 offset:4096
  ds_read_b64_tr_b16 v[182:183], v12 offset:4608
  v_mfma_f32_16x16x32_bf16 v[80:83], v[164:167], v[128:131], v[80:83]
  v_mfma_f32_16x16x32_bf16 v[84:87], v[164:167], v[132:135], v[84:87]
  v_mfma_f32_16x16x32_bf16 v[88:91], v[164:167], v[136:139], v[88:91]
  v_mfma_f32_16x16x32_bf16 v[92:95], v[164:167], v[140:143], v[92:95]
  ds_read_b64_tr_b16 v[184:185], v11 offset:12288
  ds_read_b64_tr_b16 v[186:187], v11 offset:12800
  v_mfma_f32_16x16x32_bf16 v[96:99], v[168:171], v[128:131], v[96:99]
  v_mfma_f32_16x16x32_bf16 v[100:103], v[168:171], v[132:135], v[100:103]
  v_mfma_f32_16x16x32_bf16 v[104:107], v[168:171], v[136:139], v[104:107]
  v_mfma_f32_16x16x32_bf16 v[108:111], v[168:171], v[140:143], v[108:111]
  ds_read_b64_tr_b16 v[188:189], v12 offset:12288
  ds_read_b64_tr_b16 v[190:191], v12 offset:12800
  v_mfma_f32_16x16x32_bf16 v[112:115], v[172:175], v[128:131], v[112:115]
  v_mfma_f32_16x16x32_bf16 v[116:119], v[172:175], v[132:135], v[116:119]
  v_mfma_f32_16x16x32_bf16 v[120:123], v[172:175], v[136:139], v[120:123]
  v_mfma_f32_16x16x32_bf16 v[124:127], v[172:175], v[140:143], v[124:127]
  s_waitcnt vmcnt(6) lgkmcnt(0)
  s_barrier
  s_mov_b32 s66, 768
  s_mul_i32 s67, s59, 384
  ds_read_b128 v[128:131], v7 offset:32768
  ds_read_b64_tr_b16 v[160:161], v11 offset:16384
  ds_read_b64_tr_b16 v[162:163], v11 offset:16896
  v_mfma_f32_16x16x32_bf16 v[64:67], v[176:179], v[144:147], v[64:67]
  s_add_u32 m0, s64, 0
  s_nop 0
  buffer_load_dwordx4 v2, s[20:23], s66 offen lds
  v_mfma_f32_16x16x32_bf16 v[68:71], v[176:179], v[148:151], v[68:71]
  v_mfma_f32_16x16x32_bf16 v[72:75], v[176:179], v[152:155], v[72:75]
  v_mfma_f32_16x16x32_bf16 v[76:79], v[176:179], v[156:159], v[76:79]
  s_add_u32 m0, s64, 1024
  s_nop 0
  buffer_load_dwordx4 v3, s[20:23], s66 offen lds
  ds_read_b128 v[132:135], v7 offset:34816
  ds_read_b64_tr_b16 v[164:165], v12 offset:16384
  ds_read_b64_tr_b16 v[166:167], v12 offset:16896
  v_mfma_f32_16x16x32_bf16 v[80:83], v[180:183], v[144:147], v[80:83]
  v_mfma_f32_16x16x32_bf16 v[84:87], v[180:183], v[148:151], v[84:87]
  s_add_u32 m0, s64, 2048
  s_nop 0
  buffer_load_dwordx4 v4, s[20:23], s66 offen lds
  v_mfma_f32_16x16x32_bf16 v[88:91], v[180:183], v[152:155], v[88:91]
  v_mfma_f32_16x16x32_bf16 v[92:95], v[180:183], v[156:159], v[92:95]
  ds_read_b128 v[136:139], v7 offset:36864
  ds_read_b64_tr_b16 v[168:169], v11 offset:24576
  ds_read_b64_tr_b16 v[170:171], v11 offset:25088
  v_mfma_f32_16x16x32_bf16 v[96:99], v[184:187], v[144:147], v[96:99]
  s_add_u32 m0, s64, 3072
  s_nop 0
  buffer_load_dwordx4 v5, s[20:23], s66 offen lds
  v_mfma_f32_16x16x32_bf16 v[100:103], v[184:187], v[148:151], v[100:103]
  v_mfma_f32_16x16x32_bf16 v[104:107], v[184:187], v[152:155], v[104:107]
  s_add_u32 m0, s65, 0
  s_nop 0
  buffer_load_dwordx4 v6, s[24:27], s67 offen lds
  v_mfma_f32_16x16x32_bf16 v[108:111], v[184:187], v[156:159], v[108:111]
  ds_read_b128 v[140:143], v7 offset:38912
  ds_read_b64_tr_b16 v[172:173], v12 offset:24576
  ds_read_b64_tr_b16 v[174:175], v12 offset:25088
  v_mfma_f32_16x16x32_bf16 v[112:115], v[188:191], v[144:147], v[112:115]
  v_mfma_f32_16x16x32_bf16 v[116:119], v[188:191], v[148:151], v[116:119]
  s_add_u32 m0, s65, 8192
  s_nop 0
  buffer_load_dwordx4 v6, s[28:31], s67 offen lds
  v_mfma_f32_16x16x32_bf16 v[120:123], v[188:191], v[152:155], v[120:123]
  v_mfma_f32_16x16x32_bf16 v[124:127], v[188:191], v[156:159], v[124:127]
  s_lshr_b32 s61, s2, 5
  s_bfe_u32 s62, s2, 0x30002
  s_lshl_b32 s62, s62, 3
  s_add_u32 s61, s61, s62
  s_and_b32 s62, s2, 3
  s_lshl_b32 s62, s62, 7
  s_add_u32 s61, s61, s62
  s_bfe_u32 s62, s58, 0x10001
  s_lshl_b32 s62, s62, 6
  s_add_u32 s61, s61, s62
  s_and_b32 s62, s58, 1
  s_lshl_b32 s62, s62, 10
  s_add_u32 s61, s61, s62
  s_mul_i32 s61, s61, 450
  s_and_b32 s61, s61, 0xfffffffc
  v_lshrrev_b32 v14, 5, v1
  v_mul_u32_u24 v14, 230400, v14
  v_and_b32 v15, 31, v1
  v_lshl_add_u32 v14, v15, 4, v14
  s_lshl_b32 s62, s58, 10
  s_add_u32 m0, s62, 147456
  s_cmp_ge_u32 s58, 4
  s_cbranch_scc1 K1_WT_IM_1
  buffer_load_dwordx4 v14, s[36:39], s61 offen lds
  s_branch K1_WT_DONE_1
K1_WT_IM_1:
  buffer_load_dwordx4 v14, s[40:43], s61 offen lds
K1_WT_DONE_1:
  s_bfe_u32 s61, s2, 0x10005
  s_lshl_b32 s61, s61, 1
  s_add_u32 s61, s61, 147456
  v_and_b32 v14, 255, v0
  v_lshl_add_u32 v21, v14, 1, s61
  s_lshl_b32 s61, s2, 5
  v_lshlrev_b32 v19, 13, v0
  v_add_u32 v19, s61, v19
  ds_read_b128 v[144:147], v8 offset:32768
  ds_read_b128 v[148:151], v8 offset:34816
  ds_read_b128 v[152:155], v8 offset:36864
  ds_read_b128 v[156:159], v8 offset:38912
  s_waitcnt lgkmcnt(4)
  ds_read_b64_tr_b16 v[176:177], v11 offset:20480
  ds_read_b64_tr_b16 v[178:179], v11 offset:20992
  v_mfma_f32_16x16x32_bf16 v[64:67], v[160:163], v[128:131], v[64:67]
  v_mfma_f32_16x16x32_bf16 v[68:71], v[160:163], v[132:135], v[68:71]
  v_mfma_f32_16x16x32_bf16 v[72:75], v[160:163], v[136:139], v[72:75]
  v_mfma_f32_16x16x32_bf16 v[76:79], v[160:163], v[140:143], v[76:79]
  ds_read_b64_tr_b16 v[180:181], v12 offset:20480
  ds_read_b64_tr_b16 v[182:183], v12 offset:20992
  v_mfma_f32_16x16x32_bf16 v[80:83], v[164:167], v[128:131], v[80:83]
  v_mfma_f32_16x16x32_bf16 v[84:87], v[164:167], v[132:135], v[84:87]
  v_mfma_f32_16x16x32_bf16 v[88:91], v[164:167], v[136:139], v[88:91]
  v_mfma_f32_16x16x32_bf16 v[92:95], v[164:167], v[140:143], v[92:95]
  ds_read_b64_tr_b16 v[184:185], v11 offset:28672
  ds_read_b64_tr_b16 v[186:187], v11 offset:29184
  v_mfma_f32_16x16x32_bf16 v[96:99], v[168:171], v[128:131], v[96:99]
  v_mfma_f32_16x16x32_bf16 v[100:103], v[168:171], v[132:135], v[100:103]
  v_mfma_f32_16x16x32_bf16 v[104:107], v[168:171], v[136:139], v[104:107]
  v_mfma_f32_16x16x32_bf16 v[108:111], v[168:171], v[140:143], v[108:111]
  ds_read_b64_tr_b16 v[188:189], v12 offset:28672
  ds_read_b64_tr_b16 v[190:191], v12 offset:29184
  v_mfma_f32_16x16x32_bf16 v[112:115], v[172:175], v[128:131], v[112:115]
  v_mfma_f32_16x16x32_bf16 v[116:119], v[172:175], v[132:135], v[116:119]
  v_mfma_f32_16x16x32_bf16 v[120:123], v[172:175], v[136:139], v[120:123]
  v_mfma_f32_16x16x32_bf16 v[124:127], v[172:175], v[140:143], v[124:127]
  s_waitcnt vmcnt(7) lgkmcnt(0)
  s_barrier
  ds_read_b128 v[128:131], v9 offset:0
  ds_read_b64_tr_b16 v[160:161], v11 offset:32768
  ds_read_b64_tr_b16 v[162:163], v11 offset:33280
  v_mfma_f32_16x16x32_bf16 v[64:67], v[176:179], v[144:147], v[64:67]
  buffer_load_dword v31, v30, s[4:7], s8 offen
  v_mfma_f32_16x16x32_bf16 v[68:71], v[176:179], v[148:151], v[68:71]
  v_mfma_f32_16x16x32_bf16 v[72:75], v[176:179], v[152:155], v[72:75]
  v_mfma_f32_16x16x32_bf16 v[76:79], v[176:179], v[156:159], v[76:79]
  ds_read_b128 v[132:135], v9 offset:2048
  ds_read_b64_tr_b16 v[164:165], v12 offset:32768
  ds_read_b64_tr_b16 v[166:167], v12 offset:33280
  v_mfma_f32_16x16x32_bf16 v[80:83], v[180:183], v[144:147], v[80:83]
  v_mfma_f32_16x16x32_bf16 v[84:87], v[180:183], v[148:151], v[84:87]
  v_mfma_f32_16x16x32_bf16 v[88:91], v[180:183], v[152:155], v[88:91]
  v_mfma_f32_16x16x32_bf16 v[92:95], v[180:183], v[156:159], v[92:95]
  ds_read_b128 v[136:139], v9 offset:4096
  ds_read_b64_tr_b16 v[168:169], v11 offset:40960
  ds_read_b64_tr_b16 v[170:171], v11 offset:41472
  v_mfma_f32_16x16x32_bf16 v[96:99], v[184:187], v[144:147], v[96:99]
  v_mfma_f32_16x16x32_bf16 v[100:103], v[184:187], v[148:151], v[100:103]
  v_mfma_f32_16x16x32_bf16 v[104:107], v[184:187], v[152:155], v[104:107]
  v_mfma_f32_16x16x32_bf16 v[108:111], v[184:187], v[156:159], v[108:111]
  ds_read_b128 v[140:143], v9 offset:6144
  ds_read_b64_tr_b16 v[172:173], v12 offset:40960
  ds_read_b64_tr_b16 v[174:175], v12 offset:41472
  v_mfma_f32_16x16x32_bf16 v[112:115], v[188:191], v[144:147], v[112:115]
  v_mfma_f32_16x16x32_bf16 v[116:119], v[188:191], v[148:151], v[116:119]
  v_mfma_f32_16x16x32_bf16 v[120:123], v[188:191], v[152:155], v[120:123]
  v_mfma_f32_16x16x32_bf16 v[124:127], v[188:191], v[156:159], v[124:127]
  ds_read_b128 v[144:147], v10 offset:0
  ds_read_b128 v[148:151], v10 offset:2048
  ds_read_b128 v[152:155], v10 offset:4096
  ds_read_b128 v[156:159], v10 offset:6144
  s_waitcnt lgkmcnt(4)
  ds_read_b64_tr_b16 v[176:177], v11 offset:36864
  ds_read_b64_tr_b16 v[178:179], v11 offset:37376
  v_mfma_f32_16x16x32_bf16 v[64:67], v[160:163], v[128:131], v[64:67]
  v_mfma_f32_16x16x32_bf16 v[68:71], v[160:163], v[132:135], v[68:71]
  v_mfma_f32_16x16x32_bf16 v[72:75], v[160:163], v[136:139], v[72:75]
  v_mfma_f32_16x16x32_bf16 v[76:79], v[160:163], v[140:143], v[76:79]
  ds_read_b64_tr_b16 v[180:181], v12 offset:36864
  ds_read_b64_tr_b16 v[182:183], v12 offset:37376
  v_mfma_f32_16x16x32_bf16 v[80:83], v[164:167], v[128:131], v[80:83]
  v_mfma_f32_16x16x32_bf16 v[84:87], v[164:167], v[132:135], v[84:87]
  v_mfma_f32_16x16x32_bf16 v[88:91], v[164:167], v[136:139], v[88:91]
  v_mfma_f32_16x16x32_bf16 v[92:95], v[164:167], v[140:143], v[92:95]
  ds_read_b64_tr_b16 v[184:185], v11 offset:45056
  ds_read_b64_tr_b16 v[186:187], v11 offset:45568
  v_mfma_f32_16x16x32_bf16 v[96:99], v[168:171], v[128:131], v[96:99]
  v_mfma_f32_16x16x32_bf16 v[100:103], v[168:171], v[132:135], v[100:103]
  v_mfma_f32_16x16x32_bf16 v[104:107], v[168:171], v[136:139], v[104:107]
  v_mfma_f32_16x16x32_bf16 v[108:111], v[168:171], v[140:143], v[108:111]
  ds_read_b64_tr_b16 v[188:189], v12 offset:45056
  ds_read_b64_tr_b16 v[190:191], v12 offset:45568
  v_mfma_f32_16x16x32_bf16 v[112:115], v[172:175], v[128:131], v[112:115]
  v_mfma_f32_16x16x32_bf16 v[116:119], v[172:175], v[132:135], v[116:119]
  v_mfma_f32_16x16x32_bf16 v[120:123], v[172:175], v[136:139], v[120:123]
  v_mfma_f32_16x16x32_bf16 v[124:127], v[172:175], v[140:143], v[124:127]
  s_waitcnt vmcnt(1) lgkmcnt(0)
  s_barrier
  ds_read_b128 v[128:131], v7 offset:0
  ds_read_b64_tr_b16 v[160:161], v11 offset:0
  ds_read_b64_tr_b16 v[162:163], v11 offset:512
  v_mfma_f32_16x16x32_bf16 v[64:67], v[176:179], v[144:147], v[64:67]
  ds_read_u16 v32, v21 offset:0
  ds_read_u16 v40, v21 offset:4096
  v_mfma_f32_16x16x32_bf16 v[68:71], v[176:179], v[148:151], v[68:71]
  ds_read_u16 v33, v21 offset:512
  ds_read_u16 v41, v21 offset:4608
  v_mfma_f32_16x16x32_bf16 v[72:75], v[176:179], v[152:155], v[72:75]
  ds_read_u16 v34, v21 offset:1024
  ds_read_u16 v42, v21 offset:5120
  v_mfma_f32_16x16x32_bf16 v[76:79], v[176:179], v[156:159], v[76:79]
  ds_read_u16 v35, v21 offset:1536
  ds_read_u16 v43, v21 offset:5632
  ds_read_b128 v[132:135], v7 offset:2048
  ds_read_b64_tr_b16 v[164:165], v12 offset:0
  ds_read_b64_tr_b16 v[166:167], v12 offset:512
  v_mfma_f32_16x16x32_bf16 v[80:83], v[180:183], v[144:147], v[80:83]
  ds_read_u16 v36, v21 offset:2048
  ds_read_u16 v44, v21 offset:6144
  v_mfma_f32_16x16x32_bf16 v[84:87], v[180:183], v[148:151], v[84:87]
  ds_read_u16 v37, v21 offset:2560
  ds_read_u16 v45, v21 offset:6656
  v_mfma_f32_16x16x32_bf16 v[88:91], v[180:183], v[152:155], v[88:91]
  ds_read_u16 v38, v21 offset:3072
  ds_read_u16 v46, v21 offset:7168
  v_mfma_f32_16x16x32_bf16 v[92:95], v[180:183], v[156:159], v[92:95]
  ds_read_u16 v39, v21 offset:3584
  ds_read_u16 v47, v21 offset:7680
  ds_read_b128 v[136:139], v7 offset:4096
  ds_read_b64_tr_b16 v[168:169], v11 offset:8192
  ds_read_b64_tr_b16 v[170:171], v11 offset:8704
  v_mfma_f32_16x16x32_bf16 v[96:99], v[184:187], v[144:147], v[96:99]
  v_mfma_f32_16x16x32_bf16 v[100:103], v[184:187], v[148:151], v[100:103]
  v_mfma_f32_16x16x32_bf16 v[104:107], v[184:187], v[152:155], v[104:107]
  v_mfma_f32_16x16x32_bf16 v[108:111], v[184:187], v[156:159], v[108:111]
  ds_read_b128 v[140:143], v7 offset:6144
  ds_read_b64_tr_b16 v[172:173], v12 offset:8192
  ds_read_b64_tr_b16 v[174:175], v12 offset:8704
  v_mfma_f32_16x16x32_bf16 v[112:115], v[188:191], v[144:147], v[112:115]
  v_mfma_f32_16x16x32_bf16 v[116:119], v[188:191], v[148:151], v[116:119]
  v_mfma_f32_16x16x32_bf16 v[120:123], v[188:191], v[152:155], v[120:123]
  v_mfma_f32_16x16x32_bf16 v[124:127], v[188:191], v[156:159], v[124:127]
  ds_read_b128 v[144:147], v8 offset:0
  ds_read_b128 v[148:151], v8 offset:2048
  ds_read_b128 v[152:155], v8 offset:4096
  ds_read_b128 v[156:159], v8 offset:6144
  s_waitcnt lgkmcnt(4)
  ds_read_b64_tr_b16 v[176:177], v11 offset:4096
  ds_read_b64_tr_b16 v[178:179], v11 offset:4608
  v_mfma_f32_16x16x32_bf16 v[64:67], v[160:163], v[128:131], v[64:67]
  v_mfma_f32_16x16x32_bf16 v[68:71], v[160:163], v[132:135], v[68:71]
  v_mfma_f32_16x16x32_bf16 v[72:75], v[160:163], v[136:139], v[72:75]
  v_mfma_f32_16x16x32_bf16 v[76:79], v[160:163], v[140:143], v[76:79]
  ds_read_b64_tr_b16 v[180:181], v12 offset:4096
  ds_read_b64_tr_b16 v[182:183], v12 offset:4608
  v_mfma_f32_16x16x32_bf16 v[80:83], v[164:167], v[128:131], v[80:83]
  v_mfma_f32_16x16x32_bf16 v[84:87], v[164:167], v[132:135], v[84:87]
  v_mfma_f32_16x16x32_bf16 v[88:91], v[164:167], v[136:139], v[88:91]
  v_mfma_f32_16x16x32_bf16 v[92:95], v[164:167], v[140:143], v[92:95]
  ds_read_b64_tr_b16 v[184:185], v11 offset:12288
  ds_read_b64_tr_b16 v[186:187], v11 offset:12800
  v_mfma_f32_16x16x32_bf16 v[96:99], v[168:171], v[128:131], v[96:99]
  v_mfma_f32_16x16x32_bf16 v[100:103], v[168:171], v[132:135], v[100:103]
  v_mfma_f32_16x16x32_bf16 v[104:107], v[168:171], v[136:139], v[104:107]
  v_mfma_f32_16x16x32_bf16 v[108:111], v[168:171], v[140:143], v[108:111]
  ds_read_b64_tr_b16 v[188:189], v12 offset:12288
  ds_read_b64_tr_b16 v[190:191], v12 offset:12800
  v_mfma_f32_16x16x32_bf16 v[112:115], v[172:175], v[128:131], v[112:115]
  v_mfma_f32_16x16x32_bf16 v[116:119], v[172:175], v[132:135], v[116:119]
  v_mfma_f32_16x16x32_bf16 v[120:123], v[172:175], v[136:139], v[120:123]
  v_mfma_f32_16x16x32_bf16 v[124:127], v[172:175], v[140:143], v[124:127]
  s_waitcnt lgkmcnt(0)
  v_mfma_f32_16x16x32_bf16 v[64:67], v[176:179], v[144:147], v[64:67]
  v_lshl_or_b32 v32, v40, 16, v32
  v_lshl_or_b32 v33, v41, 16, v33
  v_mfma_f32_16x16x32_bf16 v[68:71], v[176:179], v[148:151], v[68:71]
  v_lshl_or_b32 v34, v42, 16, v34
  v_lshl_or_b32 v35, v43, 16, v35
  v_mfma_f32_16x16x32_bf16 v[72:75], v[176:179], v[152:155], v[72:75]
  v_lshl_or_b32 v36, v44, 16, v36
  v_lshl_or_b32 v37, v45, 16, v37
  v_mfma_f32_16x16x32_bf16 v[76:79], v[176:179], v[156:159], v[76:79]
  v_lshl_or_b32 v38, v46, 16, v38
  v_lshl_or_b32 v39, v47, 16, v39
  v_mfma_f32_16x16x32_bf16 v[80:83], v[180:183], v[144:147], v[80:83]
  buffer_store_dwordx4 v[32:35], v19, s[44:47], 0 offen
  buffer_store_dwordx4 v[36:39], v19, s[44:47], 0 offen offset:16
  v_mfma_f32_16x16x32_bf16 v[84:87], v[180:183], v[148:151], v[84:87]
  v_mfma_f32_16x16x32_bf16 v[88:91], v[180:183], v[152:155], v[88:91]
  v_mfma_f32_16x16x32_bf16 v[92:95], v[180:183], v[156:159], v[92:95]
  v_mfma_f32_16x16x32_bf16 v[96:99], v[184:187], v[144:147], v[96:99]
  v_mfma_f32_16x16x32_bf16 v[100:103], v[184:187], v[148:151], v[100:103]
  v_mfma_f32_16x16x32_bf16 v[104:107], v[184:187], v[152:155], v[104:107]
  v_mfma_f32_16x16x32_bf16 v[108:111], v[184:187], v[156:159], v[108:111]
  v_mfma_f32_16x16x32_bf16 v[112:115], v[188:191], v[144:147], v[112:115]
  v_mfma_f32_16x16x32_bf16 v[116:119], v[188:191], v[148:151], v[116:119]
  v_mfma_f32_16x16x32_bf16 v[120:123], v[188:191], v[152:155], v[120:123]
  v_mfma_f32_16x16x32_bf16 v[124:127], v[188:191], v[156:159], v[124:127]
  s_nop 7
  s_nop 7
  v_and_b32 v14, 15, v1
  s_lshl_b32 s61, s57, 8
  s_lshr_b32 s62, s58, 1
  s_lshl_b32 s62, s62, 6
  s_add_u32 s61, s61, s62
  v_add_u32 v14, s61, v14
  v_mul_u32_u24 v14, 3584, v14
  v_bfe_u32 v15, v1, 4, 1
  v_lshl_add_u32 v14, v15, 5, v14
  v_bfe_u32 v15, v1, 5, 1
  v_lshl_add_u32 v14, v15, 4, v14
  s_lshl_b32 s61, s56, 7
  s_and_b32 s62, s58, 1
  s_lshl_b32 s62, s62, 6
  s_add_u32 s61, s61, s62
  v_add_u32 v13, s61, v14
  s_mov_b32 s68, 0
  s_mov_b32 s69, 57344
  s_mov_b32 s70, 114688
  s_mov_b32 s71, 172032
  s_mov_b32 s98, 0xbdd2d3e8
  s_mov_b32 s99, 0xbdd2d3e8
  v_mov_b32 v16, 0xc0135761
  v_mov_b32 v17, 0xc0135761
  v_pk_mul_f32 v[144:145], v[64:65], v[64:65]
  v_pk_mul_f32 v[146:147], v[66:67], v[66:67]
  v_pk_fma_f32 v[144:145], v[144:145], s[98:99], v[16:17]
  v_pk_fma_f32 v[146:147], v[146:147], s[98:99], v[16:17]
  v_pk_mul_f32 v[144:145], v[144:145], v[64:65]
  v_pk_mul_f32 v[146:147], v[146:147], v[66:67]
  v_exp_f32 v144, v144
  v_exp_f32 v145, v145
  v_exp_f32 v146, v146
  v_exp_f32 v147, v147
  v_pk_mul_f32 v[148:149], v[64:65], v[96:97]
  v_pk_mul_f32 v[150:151], v[66:67], v[98:99]
  v_pk_add_f32 v[144:145], v[144:145], 1.0 op_sel_hi:[1,0]
  v_pk_add_f32 v[146:147], v[146:147], 1.0 op_sel_hi:[1,0]
  v_rcp_f32 v144, v144
  v_rcp_f32 v145, v145
  v_rcp_f32 v146, v146
  v_rcp_f32 v147, v147
  s_nop 0
  v_pk_mul_f32 v[148:149], v[148:149], v[144:145]
  v_pk_mul_f32 v[150:151], v[150:151], v[146:147]
  v_cvt_pk_bf16_f32 v128, v148, v149
  v_cvt_pk_bf16_f32 v129, v150, v151
  v_pk_mul_f32 v[160:161], v[80:81], v[80:81]
  v_pk_mul_f32 v[162:163], v[82:83], v[82:83]
  v_pk_fma_f32 v[160:161], v[160:161], s[98:99], v[16:17]
  v_pk_fma_f32 v[162:163], v[162:163], s[98:99], v[16:17]
  v_pk_mul_f32 v[160:161], v[160:161], v[80:81]
  v_pk_mul_f32 v[162:163], v[162:163], v[82:83]
  v_exp_f32 v160, v160
  v_exp_f32 v161, v161
  v_exp_f32 v162, v162
  v_exp_f32 v163, v163
  v_pk_mul_f32 v[164:165], v[80:81], v[112:113]
  v_pk_mul_f32 v[166:167], v[82:83], v[114:115]
  v_pk_add_f32 v[160:161], v[160:161], 1.0 op_sel_hi:[1,0]
  v_pk_add_f32 v[162:163], v[162:163], 1.0 op_sel_hi:[1,0]
  v_rcp_f32 v160, v160
  v_rcp_f32 v161, v161
  v_rcp_f32 v162, v162
  v_rcp_f32 v163, v163
  s_nop 0
  v_pk_mul_f32 v[164:165], v[164:165], v[160:161]
  v_pk_mul_f32 v[166:167], v[166:167], v[162:163]
  v_cvt_pk_bf16_f32 v130, v164, v165
  v_cvt_pk_bf16_f32 v131, v166, v167
  s_nop 1
  v_permlane16_swap_b32 v128, v130
  v_permlane16_swap_b32 v129, v131
  s_nop 1
  buffer_store_dwordx4 v[128:131], v13, s[32:35], s68 offen
  v_pk_mul_f32 v[144:145], v[68:69], v[68:69]
  v_pk_mul_f32 v[146:147], v[70:71], v[70:71]
  v_pk_fma_f32 v[144:145], v[144:145], s[98:99], v[16:17]
  v_pk_fma_f32 v[146:147], v[146:147], s[98:99], v[16:17]
  v_pk_mul_f32 v[144:145], v[144:145], v[68:69]
  v_pk_mul_f32 v[146:147], v[146:147], v[70:71]
  v_exp_f32 v144, v144
  v_exp_f32 v145, v145
  v_exp_f32 v146, v146
  v_exp_f32 v147, v147
  v_pk_mul_f32 v[148:149], v[68:69], v[100:101]
  v_pk_mul_f32 v[150:151], v[70:71], v[102:103]
  v_pk_add_f32 v[144:145], v[144:145], 1.0 op_sel_hi:[1,0]
  v_pk_add_f32 v[146:147], v[146:147], 1.0 op_sel_hi:[1,0]
  v_rcp_f32 v144, v144
  v_rcp_f32 v145, v145
  v_rcp_f32 v146, v146
  v_rcp_f32 v147, v147
  s_nop 0
  v_pk_mul_f32 v[148:149], v[148:149], v[144:145]
  v_pk_mul_f32 v[150:151], v[150:151], v[146:147]
  v_cvt_pk_bf16_f32 v132, v148, v149
  v_cvt_pk_bf16_f32 v133, v150, v151
  v_pk_mul_f32 v[160:161], v[84:85], v[84:85]
  v_pk_mul_f32 v[162:163], v[86:87], v[86:87]
  v_pk_fma_f32 v[160:161], v[160:161], s[98:99], v[16:17]
  v_pk_fma_f32 v[162:163], v[162:163], s[98:99], v[16:17]
  v_pk_mul_f32 v[160:161], v[160:161], v[84:85]
  v_pk_mul_f32 v[162:163], v[162:163], v[86:87]
  v_exp_f32 v160, v160
  v_exp_f32 v161, v161
  v_exp_f32 v162, v162
  v_exp_f32 v163, v163
  v_pk_mul_f32 v[164:165], v[84:85], v[116:117]
  v_pk_mul_f32 v[166:167], v[86:87], v[118:119]
  v_pk_add_f32 v[160:161], v[160:161], 1.0 op_sel_hi:[1,0]
  v_pk_add_f32 v[162:163], v[162:163], 1.0 op_sel_hi:[1,0]
  v_rcp_f32 v160, v160
  v_rcp_f32 v161, v161
  v_rcp_f32 v162, v162
  v_rcp_f32 v163, v163
  s_nop 0
  v_pk_mul_f32 v[164:165], v[164:165], v[160:161]
  v_pk_mul_f32 v[166:167], v[166:167], v[162:163]
  v_cvt_pk_bf16_f32 v134, v164, v165
  v_cvt_pk_bf16_f32 v135, v166, v167
  s_nop 1
  v_permlane16_swap_b32 v132, v134
  v_permlane16_swap_b32 v133, v135
  s_nop 1
  buffer_store_dwordx4 v[132:135], v13, s[32:35], s69 offen
  v_pk_mul_f32 v[144:145], v[72:73], v[72:73]
  v_pk_mul_f32 v[146:147], v[74:75], v[74:75]
  v_pk_fma_f32 v[144:145], v[144:145], s[98:99], v[16:17]
  v_pk_fma_f32 v[146:147], v[146:147], s[98:99], v[16:17]
  v_pk_mul_f32 v[144:145], v[144:145], v[72:73]
  v_pk_mul_f32 v[146:147], v[146:147], v[74:75]
  v_exp_f32 v144, v144
  v_exp_f32 v145, v145
  v_exp_f32 v146, v146
  v_exp_f32 v147, v147
  v_pk_mul_f32 v[148:149], v[72:73], v[104:105]
  v_pk_mul_f32 v[150:151], v[74:75], v[106:107]
  v_pk_add_f32 v[144:145], v[144:145], 1.0 op_sel_hi:[1,0]
  v_pk_add_f32 v[146:147], v[146:147], 1.0 op_sel_hi:[1,0]
  v_rcp_f32 v144, v144
  v_rcp_f32 v145, v145
  v_rcp_f32 v146, v146
  v_rcp_f32 v147, v147
  s_nop 0
  v_pk_mul_f32 v[148:149], v[148:149], v[144:145]
  v_pk_mul_f32 v[150:151], v[150:151], v[146:147]
  v_cvt_pk_bf16_f32 v136, v148, v149
  v_cvt_pk_bf16_f32 v137, v150, v151
  v_pk_mul_f32 v[160:161], v[88:89], v[88:89]
  v_pk_mul_f32 v[162:163], v[90:91], v[90:91]
  v_pk_fma_f32 v[160:161], v[160:161], s[98:99], v[16:17]
  v_pk_fma_f32 v[162:163], v[162:163], s[98:99], v[16:17]
  v_pk_mul_f32 v[160:161], v[160:161], v[88:89]
  v_pk_mul_f32 v[162:163], v[162:163], v[90:91]
  v_exp_f32 v160, v160
  v_exp_f32 v161, v161
  v_exp_f32 v162, v162
  v_exp_f32 v163, v163
  v_pk_mul_f32 v[164:165], v[88:89], v[120:121]
  v_pk_mul_f32 v[166:167], v[90:91], v[122:123]
  v_pk_add_f32 v[160:161], v[160:161], 1.0 op_sel_hi:[1,0]
  v_pk_add_f32 v[162:163], v[162:163], 1.0 op_sel_hi:[1,0]
  v_rcp_f32 v160, v160
  v_rcp_f32 v161, v161
  v_rcp_f32 v162, v162
  v_rcp_f32 v163, v163
  s_nop 0
  v_pk_mul_f32 v[164:165], v[164:165], v[160:161]
  v_pk_mul_f32 v[166:167], v[166:167], v[162:163]
  v_cvt_pk_bf16_f32 v138, v164, v165
  v_cvt_pk_bf16_f32 v139, v166, v167
  s_nop 1
  v_permlane16_swap_b32 v136, v138
  v_permlane16_swap_b32 v137, v139
  s_nop 1
  buffer_store_dwordx4 v[136:139], v13, s[32:35], s70 offen
  v_pk_mul_f32 v[144:145], v[76:77], v[76:77]
  v_pk_mul_f32 v[146:147], v[78:79], v[78:79]
  v_pk_fma_f32 v[144:145], v[144:145], s[98:99], v[16:17]
  v_pk_fma_f32 v[146:147], v[146:147], s[98:99], v[16:17]
  v_pk_mul_f32 v[144:145], v[144:145], v[76:77]
  v_pk_mul_f32 v[146:147], v[146:147], v[78:79]
  v_exp_f32 v144, v144
  v_exp_f32 v145, v145
  v_exp_f32 v146, v146
  v_exp_f32 v147, v147
  v_pk_mul_f32 v[148:149], v[76:77], v[108:109]
  v_pk_mul_f32 v[150:151], v[78:79], v[110:111]
  v_pk_add_f32 v[144:145], v[144:145], 1.0 op_sel_hi:[1,0]
  v_pk_add_f32 v[146:147], v[146:147], 1.0 op_sel_hi:[1,0]
  v_rcp_f32 v144, v144
  v_rcp_f32 v145, v145
  v_rcp_f32 v146, v146
  v_rcp_f32 v147, v147
  s_nop 0
  v_pk_mul_f32 v[148:149], v[148:149], v[144:145]
  v_pk_mul_f32 v[150:151], v[150:151], v[146:147]
  v_cvt_pk_bf16_f32 v140, v148, v149
  v_cvt_pk_bf16_f32 v141, v150, v151
  v_pk_mul_f32 v[160:161], v[92:93], v[92:93]
  v_pk_mul_f32 v[162:163], v[94:95], v[94:95]
  v_pk_fma_f32 v[160:161], v[160:161], s[98:99], v[16:17]
  v_pk_fma_f32 v[162:163], v[162:163], s[98:99], v[16:17]
  v_pk_mul_f32 v[160:161], v[160:161], v[92:93]
  v_pk_mul_f32 v[162:163], v[162:163], v[94:95]
  v_exp_f32 v160, v160
  v_exp_f32 v161, v161
  v_exp_f32 v162, v162
  v_exp_f32 v163, v163
  v_pk_mul_f32 v[164:165], v[92:93], v[124:125]
  v_pk_mul_f32 v[166:167], v[94:95], v[126:127]
  v_pk_add_f32 v[160:161], v[160:161], 1.0 op_sel_hi:[1,0]
  v_pk_add_f32 v[162:163], v[162:163], 1.0 op_sel_hi:[1,0]
  v_rcp_f32 v160, v160
  v_rcp_f32 v161, v161
  v_rcp_f32 v162, v162
  v_rcp_f32 v163, v163
  s_nop 0
  v_pk_mul_f32 v[164:165], v[164:165], v[160:161]
  v_pk_mul_f32 v[166:167], v[166:167], v[162:163]
  v_cvt_pk_bf16_f32 v142, v164, v165
  v_cvt_pk_bf16_f32 v143, v166, v167
  s_nop 1
  v_permlane16_swap_b32 v140, v142
  v_permlane16_swap_b32 v141, v143
  s_nop 1
  buffer_store_dwordx4 v[140:143], v13, s[32:35], s71 offen
  s_endpgm
K1_DFT:
  s_waitcnt vmcnt(9)
  s_barrier
  s_mov_b32 s66, 256
  s_mul_i32 s67, s59, 128
  s_add_u32 m0, s64, 65536
  s_nop 0
  buffer_load_dwordx4 v2, s[20:23], s66 offen lds
  s_add_u32 m0, s64, 66560
  s_nop 0
  buffer_load_dwordx4 v3, s[20:23], s66 offen lds
  s_add_u32 m0, s64, 67584
  s_nop 0
  buffer_load_dwordx4 v4, s[20:23], s66 offen lds
  s_add_u32 m0, s64, 68608
  s_nop 0
  buffer_load_dwordx4 v5, s[20:23], s66 offen lds
  s_add_u32 m0, s65, 32768
  s_nop 0
  buffer_load_dwordx4 v6, s[24:27], s67 offen lds
  s_add_u32 m0, s65, 40960
  s_nop 0
  buffer_load_dwordx4 v6, s[28:31], s67 offen lds
  ds_read_b128 v[128:131], v7 offset:0
  ds_read_b128 v[132:135], v7 offset:2048
  ds_read_b128 v[136:139], v7 offset:4096
  ds_read_b128 v[140:143], v7 offset:6144
  ds_read_b64_tr_b16 v[160:161], v11 offset:0
  ds_read_b64_tr_b16 v[162:163], v11 offset:512
  ds_read_b64_tr_b16 v[164:165], v12 offset:0
  ds_read_b64_tr_b16 v[166:167], v12 offset:512
  ds_read_b64_tr_b16 v[168:169], v11 offset:8192
  ds_read_b64_tr_b16 v[170:171], v11 offset:8704
  ds_read_b64_tr_b16 v[172:173], v12 offset:8192
  ds_read_b64_tr_b16 v[174:175], v12 offset:8704
  ds_read_b128 v[144:147], v8 offset:0
  ds_read_b128 v[148:151], v8 offset:2048
  ds_read_b128 v[152:155], v8 offset:4096
  ds_read_b128 v[156:159], v8 offset:6144
  s_waitcnt lgkmcnt(4)
  ds_read_b64_tr_b16 v[176:177], v11 offset:4096
  ds_read_b64_tr_b16 v[178:179], v11 offset:4608
  v_mfma_f32_16x16x32_bf16 v[64:67], v[128:131], v[160:163], v[64:67]
  v_mfma_f32_16x16x32_bf16 v[68:71], v[132:135], v[160:163], v[68:71]
  v_mfma_f32_16x16x32_bf16 v[72:75], v[136:139], v[160:163], v[72:75]
  v_mfma_f32_16x16x32_bf16 v[76:79], v[140:143], v[160:163], v[76:79]
  ds_read_b64_tr_b16 v[180:181], v12 offset:4096
  ds_read_b64_tr_b16 v[182:183], v12 offset:4608
  v_mfma_f32_16x16x32_bf16 v[80:83], v[128:131], v[164:167], v[80:83]
  v_mfma_f32_16x16x32_bf16 v[84:87], v[132:135], v[164:167], v[84:87]
  v_mfma_f32_16x16x32_bf16 v[88:91], v[136:139], v[164:167], v[88:91]
  v_mfma_f32_16x16x32_bf16 v[92:95], v[140:143], v[164:167], v[92:95]
  ds_read_b64_tr_b16 v[184:185], v11 offset:12288
  ds_read_b64_tr_b16 v[186:187], v11 offset:12800
  v_mfma_f32_16x16x32_bf16 v[96:99], v[128:131], v[168:171], v[96:99]
  v_mfma_f32_16x16x32_bf16 v[100:103], v[132:135], v[168:171], v[100:103]
  v_mfma_f32_16x16x32_bf16 v[104:107], v[136:139], v[168:171], v[104:107]
  v_mfma_f32_16x16x32_bf16 v[108:111], v[140:143], v[168:171], v[108:111]
  ds_read_b64_tr_b16 v[188:189], v12 offset:12288
  ds_read_b64_tr_b16 v[190:191], v12 offset:12800
  v_mfma_f32_16x16x32_bf16 v[112:115], v[128:131], v[172:175], v[112:115]
  v_mfma_f32_16x16x32_bf16 v[116:119], v[132:135], v[172:175], v[116:119]
  v_mfma_f32_16x16x32_bf16 v[120:123], v[136:139], v[172:175], v[120:123]
  v_mfma_f32_16x16x32_bf16 v[124:127], v[140:143], v[172:175], v[124:127]
  s_waitcnt vmcnt(9) lgkmcnt(0)
  s_barrier
  s_mov_b32 s66, 384
  s_mul_i32 s67, s59, 192
  ds_read_b128 v[128:131], v7 offset:32768
  ds_read_b64_tr_b16 v[160:161], v11 offset:16384
  ds_read_b64_tr_b16 v[162:163], v11 offset:16896
  v_mfma_f32_16x16x32_bf16 v[64:67], v[144:147], v[176:179], v[64:67]
  s_add_u32 m0, s64, 0
  s_nop 0
  buffer_load_dwordx4 v2, s[20:23], s66 offen lds
  v_mfma_f32_16x16x32_bf16 v[68:71], v[148:151], v[176:179], v[68:71]
  v_mfma_f32_16x16x32_bf16 v[72:75], v[152:155], v[176:179], v[72:75]
  v_mfma_f32_16x16x32_bf16 v[76:79], v[156:159], v[176:179], v[76:79]
  s_add_u32 m0, s64, 1024
  s_nop 0
  buffer_load_dwordx4 v3, s[20:23], s66 offen lds
  ds_read_b128 v[132:135], v7 offset:34816
  ds_read_b64_tr_b16 v[164:165], v12 offset:16384
  ds_read_b64_tr_b16 v[166:167], v12 offset:16896
  v_mfma_f32_16x16x32_bf16 v[80:83], v[144:147], v[180:183], v[80:83]
  v_mfma_f32_16x16x32_bf16 v[84:87], v[148:151], v[180:183], v[84:87]
  s_add_u32 m0, s64, 2048
  s_nop 0
  buffer_load_dwordx4 v4, s[20:23], s66 offen lds
  v_mfma_f32_16x16x32_bf16 v[88:91], v[152:155], v[180:183], v[88:91]
  v_mfma_f32_16x16x32_bf16 v[92:95], v[156:159], v[180:183], v[92:95]
  ds_read_b128 v[136:139], v7 offset:36864
  ds_read_b64_tr_b16 v[168:169], v11 offset:24576
  ds_read_b64_tr_b16 v[170:171], v11 offset:25088
  v_mfma_f32_16x16x32_bf16 v[96:99], v[144:147], v[184:187], v[96:99]
  s_add_u32 m0, s64, 3072
  s_nop 0
  buffer_load_dwordx4 v5, s[20:23], s66 offen lds
  v_mfma_f32_16x16x32_bf16 v[100:103], v[148:151], v[184:187], v[100:103]
  v_mfma_f32_16x16x32_bf16 v[104:107], v[152:155], v[184:187], v[104:107]
  s_add_u32 m0, s65, 0
  s_nop 0
  buffer_load_dwordx4 v6, s[24:27], s67 offen lds
  v_mfma_f32_16x16x32_bf16 v[108:111], v[156:159], v[184:187], v[108:111]
  ds_read_b128 v[140:143], v7 offset:38912
  ds_read_b64_tr_b16 v[172:173], v12 offset:24576
  ds_read_b64_tr_b16 v[174:175], v12 offset:25088
  v_mfma_f32_16x16x32_bf16 v[112:115], v[144:147], v[188:191], v[112:115]
  v_mfma_f32_16x16x32_bf16 v[116:119], v[148:151], v[188:191], v[116:119]
  s_add_u32 m0, s65, 8192
  s_nop 0
  buffer_load_dwordx4 v6, s[28:31], s67 offen lds
  v_mfma_f32_16x16x32_bf16 v[120:123], v[152:155], v[188:191], v[120:123]
  v_mfma_f32_16x16x32_bf16 v[124:127], v[156:159], v[188:191], v[124:127]
  ds_read_b128 v[144:147], v8 offset:32768
  ds_read_b128 v[148:151], v8 offset:34816
  ds_read_b128 v[152:155], v8 offset:36864
  ds_read_b128 v[156:159], v8 offset:38912
  s_waitcnt lgkmcnt(4)
  ds_read_b64_tr_b16 v[176:177], v11 offset:20480
  ds_read_b64_tr_b16 v[178:179], v11 offset:20992
  v_mfma_f32_16x16x32_bf16 v[64:67], v[128:131], v[160:163], v[64:67]
  v_mfma_f32_16x16x32_bf16 v[68:71], v[132:135], v[160:163], v[68:71]
  v_mfma_f32_16x16x32_bf16 v[72:75], v[136:139], v[160:163], v[72:75]
  v_mfma_f32_16x16x32_bf16 v[76:79], v[140:143], v[160:163], v[76:79]
  ds_read_b64_tr_b16 v[180:181], v12 offset:20480
  ds_read_b64_tr_b16 v[182:183], v12 offset:20992
  v_mfma_f32_16x16x32_bf16 v[80:83], v[128:131], v[164:167], v[80:83]
  v_mfma_f32_16x16x32_bf16 v[84:87], v[132:135], v[164:167], v[84:87]
  v_mfma_f32_16x16x32_bf16 v[88:91], v[136:139], v[164:167], v[88:91]
  v_mfma_f32_16x16x32_bf16 v[92:95], v[140:143], v[164:167], v[92:95]
  ds_read_b64_tr_b16 v[184:185], v11 offset:28672
  ds_read_b64_tr_b16 v[186:187], v11 offset:29184
  v_mfma_f32_16x16x32_bf16 v[96:99], v[128:131], v[168:171], v[96:99]
  v_mfma_f32_16x16x32_bf16 v[100:103], v[132:135], v[168:171], v[100:103]
  v_mfma_f32_16x16x32_bf16 v[104:107], v[136:139], v[168:171], v[104:107]
  v_mfma_f32_16x16x32_bf16 v[108:111], v[140:143], v[168:171], v[108:111]
  ds_read_b64_tr_b16 v[188:189], v12 offset:28672
  ds_read_b64_tr_b16 v[190:191], v12 offset:29184
  v_mfma_f32_16x16x32_bf16 v[112:115], v[128:131], v[172:175], v[112:115]
  v_mfma_f32_16x16x32_bf16 v[116:119], v[132:135], v[172:175], v[116:119]
  v_mfma_f32_16x16x32_bf16 v[120:123], v[136:139], v[172:175], v[120:123]
  v_mfma_f32_16x16x32_bf16 v[124:127], v[140:143], v[172:175], v[124:127]
  s_waitcnt vmcnt(6) lgkmcnt(0)
  s_barrier
  s_mov_b32 s66, 512
  s_mul_i32 s67, s59, 256
  ds_read_b128 v[128:131], v9 offset:0
  ds_read_b64_tr_b16 v[160:161], v11 offset:32768
  ds_read_b64_tr_b16 v[162:163], v11 offset:33280
  v_mfma_f32_16x16x32_bf16 v[64:67], v[144:147], v[176:179], v[64:67]
  s_add_u32 m0, s64, 32768
  s_nop 0
  buffer_load_dwordx4 v2, s[20:23], s66 offen lds
  v_mfma_f32_16x16x32_bf16 v[68:71], v[148:151], v[176:179], v[68:71]
  v_lshlrev_b32 v200, 16, v196
  v_and_b32 v201, 0xffff0000, v196
  v_mfma_f32_16x16x32_bf16 v[72:75], v[152:155], v[176:179], v[72:75]
  v_lshlrev_b32 v208, 16, v192
  v_and_b32 v209, 0xffff0000, v192
  v_mfma_f32_16x16x32_bf16 v[76:79], v[156:159], v[176:179], v[76:79]
  s_add_u32 m0, s64, 33792
  s_nop 0
  buffer_load_dwordx4 v3, s[20:23], s66 offen lds
  ds_read_b128 v[132:135], v9 offset:2048
  ds_read_b64_tr_b16 v[164:165], v12 offset:32768
  ds_read_b64_tr_b16 v[166:167], v12 offset:33280
  v_mfma_f32_16x16x32_bf16 v[80:83], v[144:147], v[180:183], v[80:83]
  v_lshlrev_b32 v202, 16, v197
  v_and_b32 v203, 0xffff0000, v197
  v_mfma_f32_16x16x32_bf16 v[84:87], v[148:151], v[180:183], v[84:87]
  s_add_u32 m0, s64, 34816
  s_nop 0
  buffer_load_dwordx4 v4, s[20:23], s66 offen lds
  v_mfma_f32_16x16x32_bf16 v[88:91], v[152:155], v[180:183], v[88:91]
  v_lshlrev_b32 v210, 16, v193
  v_and_b32 v211, 0xffff0000, v193
  v_mfma_f32_16x16x32_bf16 v[92:95], v[156:159], v[180:183], v[92:95]
  v_lshlrev_b32 v204, 16, v198
  v_and_b32 v205, 0xffff0000, v198
  ds_read_b128 v[136:139], v9 offset:4096
  ds_read_b64_tr_b16 v[168:169], v11 offset:40960
  ds_read_b64_tr_b16 v[170:171], v11 offset:41472
  v_mfma_f32_16x16x32_bf16 v[96:99], v[144:147], v[184:187], v[96:99]
  s_add_u32 m0, s64, 35840
  s_nop 0
  buffer_load_dwordx4 v5, s[20:23], s66 offen lds
  v_mfma_f32_16x16x32_bf16 v[100:103], v[148:151], v[184:187], v[100:103]
  v_lshlrev_b32 v212, 16, v194
  v_and_b32 v213, 0xffff0000, v194
  v_mfma_f32_16x16x32_bf16 v[104:107], v[152:155], v[184:187], v[104:107]
  s_add_u32 m0, s65, 16384
  s_nop 0
  buffer_load_dwordx4 v6, s[24:27], s67 offen lds
  v_mfma_f32_16x16x32_bf16 v[108:111], v[156:159], v[184:187], v[108:111]
  v_lshlrev_b32 v206, 16, v199
  v_and_b32 v207, 0xffff0000, v199
  ds_read_b128 v[140:143], v9 offset:6144
  ds_read_b64_tr_b16 v[172:173], v12 offset:40960
  ds_read_b64_tr_b16 v[174:175], v12 offset:41472
  v_mfma_f32_16x16x32_bf16 v[112:115], v[144:147], v[188:191], v[112:115]
  v_lshlrev_b32 v214, 16, v195
  v_and_b32 v215, 0xffff0000, v195
  v_mfma_f32_16x16x32_bf16 v[116:119], v[148:151], v[188:191], v[116:119]
  s_add_u32 m0, s65, 24576
  s_nop 0
  buffer_load_dwordx4 v6, s[28:31], s67 offen lds
  v_mfma_f32_16x16x32_bf16 v[120:123], v[152:155], v[188:191], v[120:123]
  v_pk_mul_f32 v[208:209], v[208:209], v[200:201]
  v_pk_mul_f32 v[210:211], v[210:211], v[202:203]
  v_mfma_f32_16x16x32_bf16 v[124:127], v[156:159], v[188:191], v[124:127]
  v_pk_mul_f32 v[212:213], v[212:213], v[204:205]
  v_pk_mul_f32 v[214:215], v[214:215], v[206:207]
  ds_read_b128 v[144:147], v10 offset:0
  ds_read_b128 v[148:151], v10 offset:2048
  ds_read_b128 v[152:155], v10 offset:4096
  ds_read_b128 v[156:159], v10 offset:6144
  s_waitcnt lgkmcnt(4)
  ds_read_b64_tr_b16 v[176:177], v11 offset:36864
  ds_read_b64_tr_b16 v[178:179], v11 offset:37376
  v_mfma_f32_16x16x32_bf16 v[64:67], v[128:131], v[160:163], v[64:67]
  v_cvt_pk_bf16_f32 v216, v208, v209
  v_lshlrev_b32 v208, 16, v216
  v_mfma_f32_16x16x32_bf16 v[68:71], v[132:135], v[160:163], v[68:71]
  v_and_b32 v209, 0xffff0000, v216
  v_cvt_pk_bf16_f32 v217, v210, v211
  v_mfma_f32_16x16x32_bf16 v[72:75], v[136:139], v[160:163], v[72:75]
  v_lshlrev_b32 v210, 16, v217
  v_and_b32 v211, 0xffff0000, v217
  v_mfma_f32_16x16x32_bf16 v[76:79], v[140:143], v[160:163], v[76:79]
  v_cvt_pk_bf16_f32 v218, v212, v213
  v_lshlrev_b32 v212, 16, v218
  ds_read_b64_tr_b16 v[180:181], v12 offset:36864
  ds_read_b64_tr_b16 v[182:183], v12 offset:37376
  v_mfma_f32_16x16x32_bf16 v[80:83], v[128:131], v[164:167], v[80:83]
  v_and_b32 v213, 0xffff0000, v218
  v_cvt_pk_bf16_f32 v219, v214, v215
  v_mfma_f32_16x16x32_bf16 v[84:87], v[132:135], v[164:167], v[84:87]
  v_lshlrev_b32 v214, 16, v219
  v_and_b32 v215, 0xffff0000, v219
  v_mfma_f32_16x16x32_bf16 v[88:91], v[136:139], v[164:167], v[88:91]
  v_pk_add_f32 v[208:209], v[208:209], v[210:211]
  v_pk_add_f32 v[212:213], v[212:213], v[214:215]
  v_mfma_f32_16x16x32_bf16 v[92:95], v[140:143], v[164:167], v[92:95]
  v_pk_add_f32 v[208:209], v[208:209], v[212:213]
  v_add_f32 v208, v208, v209
  ds_read_b64_tr_b16 v[184:185], v11 offset:45056
  ds_read_b64_tr_b16 v[186:187], v11 offset:45568
  v_mfma_f32_16x16x32_bf16 v[96:99], v[128:131], v[168:171], v[96:99]
  s_nop 1
  v_add_f32_dpp v208, v208, v208 row_shr:1 row_mask:0xf bank_mask:0xf bound_ctrl:0
  v_mfma_f32_16x16x32_bf16 v[100:103], v[132:135], v[168:171], v[100:103]
  s_nop 1
  v_add_f32_dpp v208, v208, v208 row_shr:2 row_mask:0xf bank_mask:0xf bound_ctrl:0
  v_mfma_f32_16x16x32_bf16 v[104:107], v[136:139], v[168:171], v[104:107]
  s_nop 1
  v_add_f32_dpp v208, v208, v208 row_shr:4 row_mask:0xf bank_mask:0xf bound_ctrl:0
  v_mfma_f32_16x16x32_bf16 v[108:111], v[140:143], v[168:171], v[108:111]
  s_nop 1
  v_add_f32_dpp v208, v208, v208 row_shr:8 row_mask:0xf bank_mask:0xf bound_ctrl:0
  ds_read_b64_tr_b16 v[188:189], v12 offset:45056
  ds_read_b64_tr_b16 v[190:191], v12 offset:45568
  v_mfma_f32_16x16x32_bf16 v[112:115], v[128:131], v[172:175], v[112:115]
  s_nop 1
  v_add_f32_dpp v208, v208, v208 row_bcast:15 row_mask:0xa bank_mask:0xf
  v_mfma_f32_16x16x32_bf16 v[116:119], v[132:135], v[172:175], v[116:119]
  s_nop 1
  v_add_f32_dpp v208, v208, v208 row_bcast:31 row_mask:0xc bank_mask:0xf
  v_mfma_f32_16x16x32_bf16 v[120:123], v[136:139], v[172:175], v[120:123]
  v_cvt_pk_bf16_f32 v208, v208, v208
  v_lshlrev_b32 v208, 16, v208
  v_mfma_f32_16x16x32_bf16 v[124:127], v[140:143], v[172:175], v[124:127]
  v_mul_f32 v208, 0xbfb8aa3b, v208
  v_exp_f32 v208, v208
  s_waitcnt vmcnt(6) lgkmcnt(0)
  s_barrier
  s_mov_b32 s66, 640
  s_mul_i32 s67, s59, 320
  ds_read_b128 v[128:131], v7 offset:0
  ds_read_b64_tr_b16 v[160:161], v11 offset:0
  ds_read_b64_tr_b16 v[162:163], v11 offset:512
  v_mfma_f32_16x16x32_bf16 v[64:67], v[144:147], v[176:179], v[64:67]
  s_add_u32 m0, s64, 65536
  s_nop 0
  buffer_load_dwordx4 v2, s[20:23], s66 offen lds
  v_mfma_f32_16x16x32_bf16 v[68:71], v[148:151], v[176:179], v[68:71]
  s_nop 0
  v_add_f32 v208, 1.0, v208
  v_mfma_f32_16x16x32_bf16 v[72:75], v[152:155], v[176:179], v[72:75]
  v_rcp_f32 v208, v208
  s_nop 0
  v_mfma_f32_16x16x32_bf16 v[76:79], v[156:159], v[176:179], v[76:79]
  s_add_u32 m0, s64, 66560
  s_nop 0
  buffer_load_dwordx4 v3, s[20:23], s66 offen lds
  ds_read_b128 v[132:135], v7 offset:2048
  ds_read_b64_tr_b16 v[164:165], v12 offset:0
  ds_read_b64_tr_b16 v[166:167], v12 offset:512
  v_mfma_f32_16x16x32_bf16 v[80:83], v[144:147], v[180:183], v[80:83]
  v_cvt_pk_bf16_f32 v208, v208, v208
  v_lshlrev_b32 v208, 16, v208
  v_mfma_f32_16x16x32_bf16 v[84:87], v[148:151], v[180:183], v[84:87]
  s_add_u32 m0, s64, 67584
  s_nop 0
  buffer_load_dwordx4 v4, s[20:23], s66 offen lds
  v_mfma_f32_16x16x32_bf16 v[88:91], v[152:155], v[180:183], v[88:91]
  buffer_store_dword v208, v20, s[52:55], 0 offen
  v_mfma_f32_16x16x32_bf16 v[92:95], v[156:159], v[180:183], v[92:95]
  ds_read_b128 v[136:139], v7 offset:4096
  ds_read_b64_tr_b16 v[168:169], v11 offset:8192
  ds_read_b64_tr_b16 v[170:171], v11 offset:8704
  v_mfma_f32_16x16x32_bf16 v[96:99], v[144:147], v[184:187], v[96:99]
  s_add_u32 m0, s64, 68608
  s_nop 0
  buffer_load_dwordx4 v5, s[20:23], s66 offen lds
  v_mfma_f32_16x16x32_bf16 v[100:103], v[148:151], v[184:187], v[100:103]
  v_mfma_f32_16x16x32_bf16 v[104:107], v[152:155], v[184:187], v[104:107]
  s_add_u32 m0, s65, 32768
  s_nop 0
  buffer_load_dwordx4 v6, s[24:27], s67 offen lds
  v_mfma_f32_16x16x32_bf16 v[108:111], v[156:159], v[184:187], v[108:111]
  ds_read_b128 v[140:143], v7 offset:6144
  ds_read_b64_tr_b16 v[172:173], v12 offset:8192
  ds_read_b64_tr_b16 v[174:175], v12 offset:8704
  v_mfma_f32_16x16x32_bf16 v[112:115], v[144:147], v[188:191], v[112:115]
  v_mfma_f32_16x16x32_bf16 v[116:119], v[148:151], v[188:191], v[116:119]
  s_add_u32 m0, s65, 40960
  s_nop 0
  buffer_load_dwordx4 v6, s[28:31], s67 offen lds
  v_mfma_f32_16x16x32_bf16 v[120:123], v[152:155], v[188:191], v[120:123]
  v_mfma_f32_16x16x32_bf16 v[124:127], v[156:159], v[188:191], v[124:127]
  ds_read_b128 v[144:147], v8 offset:0
  ds_read_b128 v[148:151], v8 offset:2048
  ds_read_b128 v[152:155], v8 offset:4096
  ds_read_b128 v[156:159], v8 offset:6144
  s_waitcnt lgkmcnt(4)
  ds_read_b64_tr_b16 v[176:177], v11 offset:4096
  ds_read_b64_tr_b16 v[178:179], v11 offset:4608
  v_mfma_f32_16x16x32_bf16 v[64:67], v[128:131], v[160:163], v[64:67]
  v_mfma_f32_16x16x32_bf16 v[68:71], v[132:135], v[160:163], v[68:71]
  v_mfma_f32_16x16x32_bf16 v[72:75], v[136:139], v[160:163], v[72:75]
  v_mfma_f32_16x16x32_bf16 v[76:79], v[140:143], v[160:163], v[76:79]
  ds_read_b64_tr_b16 v[180:181], v12 offset:4096
  ds_read_b64_tr_b16 v[182:183], v12 offset:4608
  v_mfma_f32_16x16x32_bf16 v[80:83], v[128:131], v[164:167], v[80:83]
  v_mfma_f32_16x16x32_bf16 v[84:87], v[132:135], v[164:167], v[84:87]
  v_mfma_f32_16x16x32_bf16 v[88:91], v[136:139], v[164:167], v[88:91]
  v_mfma_f32_16x16x32_bf16 v[92:95], v[140:143], v[164:167], v[92:95]
  ds_read_b64_tr_b16 v[184:185], v11 offset:12288
  ds_read_b64_tr_b16 v[186:187], v11 offset:12800
  v_mfma_f32_16x16x32_bf16 v[96:99], v[128:131], v[168:171], v[96:99]
  v_mfma_f32_16x16x32_bf16 v[100:103], v[132:135], v[168:171], v[100:103]
  v_mfma_f32_16x16x32_bf16 v[104:107], v[136:139], v[168:171], v[104:107]
  v_mfma_f32_16x16x32_bf16 v[108:111], v[140:143], v[168:171], v[108:111]
  ds_read_b64_tr_b16 v[188:189], v12 offset:12288
  ds_read_b64_tr_b16 v[190:191], v12 offset:12800
  v_mfma_f32_16x16x32_bf16 v[112:115], v[128:131], v[172:175], v[112:115]
  v_mfma_f32_16x16x32_bf16 v[116:119], v[132:135], v[172:175], v[116:119]
  v_mfma_f32_16x16x32_bf16 v[120:123], v[136:139], v[172:175], v[120:123]
  v_mfma_f32_16x16x32_bf16 v[124:127], v[140:143], v[172:175], v[124:127]
  s_waitcnt vmcnt(6) lgkmcnt(0)
  s_barrier
  s_mov_b32 s66, 768
  s_mul_i32 s67, s59, 384
  ds_read_b128 v[128:131], v7 offset:32768
  ds_read_b64_tr_b16 v[160:161], v11 offset:16384
  ds_read_b64_tr_b16 v[162:163], v11 offset:16896
  v_mfma_f32_16x16x32_bf16 v[64:67], v[144:147], v[176:179], v[64:67]
  s_add_u32 m0, s64, 0
  s_nop 0
  buffer_load_dwordx4 v2, s[20:23], s66 offen lds
  v_mfma_f32_16x16x32_bf16 v[68:71], v[148:151], v[176:179], v[68:71]
  v_mfma_f32_16x16x32_bf16 v[72:75], v[152:155], v[176:179], v[72:75]
  v_mfma_f32_16x16x32_bf16 v[76:79], v[156:159], v[176:179], v[76:79]
  s_add_u32 m0, s64, 1024
  s_nop 0
  buffer_load_dwordx4 v3, s[20:23], s66 offen lds
  ds_read_b128 v[132:135], v7 offset:34816
  ds_read_b64_tr_b16 v[164:165], v12 offset:16384
  ds_read_b64_tr_b16 v[166:167], v12 offset:16896
  v_mfma_f32_16x16x32_bf16 v[80:83], v[144:147], v[180:183], v[80:83]
  v_mfma_f32_16x16x32_bf16 v[84:87], v[148:151], v[180:183], v[84:87]
  s_add_u32 m0, s64, 2048
  s_nop 0
  buffer_load_dwordx4 v4, s[20:23], s66 offen lds
  v_mfma_f32_16x16x32_bf16 v[88:91], v[152:155], v[180:183], v[88:91]
  v_mfma_f32_16x16x32_bf16 v[92:95], v[156:159], v[180:183], v[92:95]
  ds_read_b128 v[136:139], v7 offset:36864
  ds_read_b64_tr_b16 v[168:169], v11 offset:24576
  ds_read_b64_tr_b16 v[170:171], v11 offset:25088
  v_mfma_f32_16x16x32_bf16 v[96:99], v[144:147], v[184:187], v[96:99]
  s_add_u32 m0, s64, 3072
  s_nop 0
  buffer_load_dwordx4 v5, s[20:23], s66 offen lds
  v_mfma_f32_16x16x32_bf16 v[100:103], v[148:151], v[184:187], v[100:103]
  v_mfma_f32_16x16x32_bf16 v[104:107], v[152:155], v[184:187], v[104:107]
  s_add_u32 m0, s65, 0
  s_nop 0
  buffer_load_dwordx4 v6, s[24:27], s67 offen lds
  v_mfma_f32_16x16x32_bf16 v[108:111], v[156:159], v[184:187], v[108:111]
  ds_read_b128 v[140:143], v7 offset:38912
  ds_read_b64_tr_b16 v[172:173], v12 offset:24576
  ds_read_b64_tr_b16 v[174:175], v12 offset:25088
  v_mfma_f32_16x16x32_bf16 v[112:115], v[144:147], v[188:191], v[112:115]
  v_mfma_f32_16x16x32_bf16 v[116:119], v[148:151], v[188:191], v[116:119]
  s_add_u32 m0, s65, 8192
  s_nop 0
  buffer_load_dwordx4 v6, s[28:31], s67 offen lds
  v_mfma_f32_16x16x32_bf16 v[120:123], v[152:155], v[188:191], v[120:123]
  v_mfma_f32_16x16x32_bf16 v[124:127], v[156:159], v[188:191], v[124:127]
  s_lshr_b32 s61, s2, 5
  s_bfe_u32 s62, s2, 0x30002
  s_lshl_b32 s62, s62, 3
  s_add_u32 s61, s61, s62
  s_and_b32 s62, s2, 3
  s_lshl_b32 s62, s62, 7
  s_add_u32 s61, s61, s62
  s_bfe_u32 s62, s58, 0x10001
  s_lshl_b32 s62, s62, 6
  s_add_u32 s61, s61, s62
  s_and_b32 s62, s58, 1
  s_lshl_b32 s62, s62, 10
  s_add_u32 s61, s61, s62
  s_mul_i32 s61, s61, 450
  s_and_b32 s61, s61, 0xfffffffc
  v_lshrrev_b32 v14, 5, v1
  v_mul_u32_u24 v14, 230400, v14
  v_and_b32 v15, 31, v1
  v_lshl_add_u32 v14, v15, 4, v14
  s_lshl_b32 s62, s58, 10
  s_add_u32 m0, s62, 147456
  s_cmp_ge_u32 s58, 4
  s_cbranch_scc1 K1_WT_IM_0
  buffer_load_dwordx4 v14, s[36:39], s61 offen lds
  s_branch K1_WT_DONE_0
K1_WT_IM_0:
  buffer_load_dwordx4 v14, s[40:43], s61 offen lds
K1_WT_DONE_0:
  s_bfe_u32 s61, s2, 0x10005
  s_lshl_b32 s61, s61, 1
  s_add_u32 s61, s61, 147456
  v_and_b32 v14, 255, v0
  v_lshl_add_u32 v21, v14, 1, s61
  s_lshl_b32 s61, s2, 5
  v_lshlrev_b32 v19, 13, v0
  v_add_u32 v19, s61, v19
  ds_read_b128 v[144:147], v8 offset:32768
  ds_read_b128 v[148:151], v8 offset:34816
  ds_read_b128 v[152:155], v8 offset:36864
  ds_read_b128 v[156:159], v8 offset:38912
  s_waitcnt lgkmcnt(4)
  ds_read_b64_tr_b16 v[176:177], v11 offset:20480
  ds_read_b64_tr_b16 v[178:179], v11 offset:20992
  v_mfma_f32_16x16x32_bf16 v[64:67], v[128:131], v[160:163], v[64:67]
  v_mfma_f32_16x16x32_bf16 v[68:71], v[132:135], v[160:163], v[68:71]
  v_mfma_f32_16x16x32_bf16 v[72:75], v[136:139], v[160:163], v[72:75]
  v_mfma_f32_16x16x32_bf16 v[76:79], v[140:143], v[160:163], v[76:79]
  ds_read_b64_tr_b16 v[180:181], v12 offset:20480
  ds_read_b64_tr_b16 v[182:183], v12 offset:20992
  v_mfma_f32_16x16x32_bf16 v[80:83], v[128:131], v[164:167], v[80:83]
  v_mfma_f32_16x16x32_bf16 v[84:87], v[132:135], v[164:167], v[84:87]
  v_mfma_f32_16x16x32_bf16 v[88:91], v[136:139], v[164:167], v[88:91]
  v_mfma_f32_16x16x32_bf16 v[92:95], v[140:143], v[164:167], v[92:95]
  ds_read_b64_tr_b16 v[184:185], v11 offset:28672
  ds_read_b64_tr_b16 v[186:187], v11 offset:29184
  v_mfma_f32_16x16x32_bf16 v[96:99], v[128:131], v[168:171], v[96:99]
  v_mfma_f32_16x16x32_bf16 v[100:103], v[132:135], v[168:171], v[100:103]
  v_mfma_f32_16x16x32_bf16 v[104:107], v[136:139], v[168:171], v[104:107]
  v_mfma_f32_16x16x32_bf16 v[108:111], v[140:143], v[168:171], v[108:111]
  ds_read_b64_tr_b16 v[188:189], v12 offset:28672
  ds_read_b64_tr_b16 v[190:191], v12 offset:29184
  v_mfma_f32_16x16x32_bf16 v[112:115], v[128:131], v[172:175], v[112:115]
  v_mfma_f32_16x16x32_bf16 v[116:119], v[132:135], v[172:175], v[116:119]
  v_mfma_f32_16x16x32_bf16 v[120:123], v[136:139], v[172:175], v[120:123]
  v_mfma_f32_16x16x32_bf16 v[124:127], v[140:143], v[172:175], v[124:127]
  s_waitcnt vmcnt(7) lgkmcnt(0)
  s_barrier
  ds_read_b128 v[128:131], v9 offset:0
  ds_read_b64_tr_b16 v[160:161], v11 offset:32768
  ds_read_b64_tr_b16 v[162:163], v11 offset:33280
  v_mfma_f32_16x16x32_bf16 v[64:67], v[144:147], v[176:179], v[64:67]
  buffer_load_dword v31, v30, s[4:7], s8 offen
  v_mfma_f32_16x16x32_bf16 v[68:71], v[148:151], v[176:179], v[68:71]
  v_mfma_f32_16x16x32_bf16 v[72:75], v[152:155], v[176:179], v[72:75]
  v_mfma_f32_16x16x32_bf16 v[76:79], v[156:159], v[176:179], v[76:79]
  ds_read_b128 v[132:135], v9 offset:2048
  ds_read_b64_tr_b16 v[164:165], v12 offset:32768
  ds_read_b64_tr_b16 v[166:167], v12 offset:33280
  v_mfma_f32_16x16x32_bf16 v[80:83], v[144:147], v[180:183], v[80:83]
  v_mfma_f32_16x16x32_bf16 v[84:87], v[148:151], v[180:183], v[84:87]
  v_mfma_f32_16x16x32_bf16 v[88:91], v[152:155], v[180:183], v[88:91]
  v_mfma_f32_16x16x32_bf16 v[92:95], v[156:159], v[180:183], v[92:95]
  ds_read_b128 v[136:139], v9 offset:4096
  ds_read_b64_tr_b16 v[168:169], v11 offset:40960
  ds_read_b64_tr_b16 v[170:171], v11 offset:41472
  v_mfma_f32_16x16x32_bf16 v[96:99], v[144:147], v[184:187], v[96:99]
  v_mfma_f32_16x16x32_bf16 v[100:103], v[148:151], v[184:187], v[100:103]
  v_mfma_f32_16x16x32_bf16 v[104:107], v[152:155], v[184:187], v[104:107]
  v_mfma_f32_16x16x32_bf16 v[108:111], v[156:159], v[184:187], v[108:111]
  ds_read_b128 v[140:143], v9 offset:6144
  ds_read_b64_tr_b16 v[172:173], v12 offset:40960
  ds_read_b64_tr_b16 v[174:175], v12 offset:41472
  v_mfma_f32_16x16x32_bf16 v[112:115], v[144:147], v[188:191], v[112:115]
  v_mfma_f32_16x16x32_bf16 v[116:119], v[148:151], v[188:191], v[116:119]
  v_mfma_f32_16x16x32_bf16 v[120:123], v[152:155], v[188:191], v[120:123]
  v_mfma_f32_16x16x32_bf16 v[124:127], v[156:159], v[188:191], v[124:127]
  ds_read_b128 v[144:147], v10 offset:0
  ds_read_b128 v[148:151], v10 offset:2048
  ds_read_b128 v[152:155], v10 offset:4096
  ds_read_b128 v[156:159], v10 offset:6144
  s_waitcnt lgkmcnt(4)
  ds_read_b64_tr_b16 v[176:177], v11 offset:36864
  ds_read_b64_tr_b16 v[178:179], v11 offset:37376
  v_mfma_f32_16x16x32_bf16 v[64:67], v[128:131], v[160:163], v[64:67]
  v_mfma_f32_16x16x32_bf16 v[68:71], v[132:135], v[160:163], v[68:71]
  v_mfma_f32_16x16x32_bf16 v[72:75], v[136:139], v[160:163], v[72:75]
  v_mfma_f32_16x16x32_bf16 v[76:79], v[140:143], v[160:163], v[76:79]
  ds_read_b64_tr_b16 v[180:181], v12 offset:36864
  ds_read_b64_tr_b16 v[182:183], v12 offset:37376
  v_mfma_f32_16x16x32_bf16 v[80:83], v[128:131], v[164:167], v[80:83]
  v_mfma_f32_16x16x32_bf16 v[84:87], v[132:135], v[164:167], v[84:87]
  v_mfma_f32_16x16x32_bf16 v[88:91], v[136:139], v[164:167], v[88:91]
  v_mfma_f32_16x16x32_bf16 v[92:95], v[140:143], v[164:167], v[92:95]
  ds_read_b64_tr_b16 v[184:185], v11 offset:45056
  ds_read_b64_tr_b16 v[186:187], v11 offset:45568
  v_mfma_f32_16x16x32_bf16 v[96:99], v[128:131], v[168:171], v[96:99]
  v_mfma_f32_16x16x32_bf16 v[100:103], v[132:135], v[168:171], v[100:103]
  v_mfma_f32_16x16x32_bf16 v[104:107], v[136:139], v[168:171], v[104:107]
  v_mfma_f32_16x16x32_bf16 v[108:111], v[140:143], v[168:171], v[108:111]
  ds_read_b64_tr_b16 v[188:189], v12 offset:45056
  ds_read_b64_tr_b16 v[190:191], v12 offset:45568
  v_mfma_f32_16x16x32_bf16 v[112:115], v[128:131], v[172:175], v[112:115]
  v_mfma_f32_16x16x32_bf16 v[116:119], v[132:135], v[172:175], v[116:119]
  v_mfma_f32_16x16x32_bf16 v[120:123], v[136:139], v[172:175], v[120:123]
  v_mfma_f32_16x16x32_bf16 v[124:127], v[140:143], v[172:175], v[124:127]
  s_waitcnt vmcnt(1) lgkmcnt(0)
  s_barrier
  ds_read_b128 v[128:131], v7 offset:0
  ds_read_b64_tr_b16 v[160:161], v11 offset:0
  ds_read_b64_tr_b16 v[162:163], v11 offset:512
  v_mfma_f32_16x16x32_bf16 v[64:67], v[144:147], v[176:179], v[64:67]
  ds_read_u16 v32, v21 offset:0
  ds_read_u16 v40, v21 offset:4096
  v_mfma_f32_16x16x32_bf16 v[68:71], v[148:151], v[176:179], v[68:71]
  ds_read_u16 v33, v21 offset:512
  ds_read_u16 v41, v21 offset:4608
  v_mfma_f32_16x16x32_bf16 v[72:75], v[152:155], v[176:179], v[72:75]
  ds_read_u16 v34, v21 offset:1024
  ds_read_u16 v42, v21 offset:5120
  v_mfma_f32_16x16x32_bf16 v[76:79], v[156:159], v[176:179], v[76:79]
  ds_read_u16 v35, v21 offset:1536
  ds_read_u16 v43, v21 offset:5632
  ds_read_b128 v[132:135], v7 offset:2048
  ds_read_b64_tr_b16 v[164:165], v12 offset:0
  ds_read_b64_tr_b16 v[166:167], v12 offset:512
  v_mfma_f32_16x16x32_bf16 v[80:83], v[144:147], v[180:183], v[80:83]
  ds_read_u16 v36, v21 offset:2048
  ds_read_u16 v44, v21 offset:6144
  v_mfma_f32_16x16x32_bf16 v[84:87], v[148:151], v[180:183], v[84:87]
  ds_read_u16 v37, v21 offset:2560
  ds_read_u16 v45, v21 offset:6656
  v_mfma_f32_16x16x32_bf16 v[88:91], v[152:155], v[180:183], v[88:91]
  ds_read_u16 v38, v21 offset:3072
  ds_read_u16 v46, v21 offset:7168
  v_mfma_f32_16x16x32_bf16 v[92:95], v[156:159], v[180:183], v[92:95]
  ds_read_u16 v39, v21 offset:3584
  ds_read_u16 v47, v21 offset:7680
  ds_read_b128 v[136:139], v7 offset:4096
  ds_read_b64_tr_b16 v[168:169], v11 offset:8192
  ds_read_b64_tr_b16 v[170:171], v11 offset:8704
  v_mfma_f32_16x16x32_bf16 v[96:99], v[144:147], v[184:187], v[96:99]
  v_mfma_f32_16x16x32_bf16 v[100:103], v[148:151], v[184:187], v[100:103]
  v_mfma_f32_16x16x32_bf16 v[104:107], v[152:155], v[184:187], v[104:107]
  v_mfma_f32_16x16x32_bf16 v[108:111], v[156:159], v[184:187], v[108:111]
  ds_read_b128 v[140:143], v7 offset:6144
  ds_read_b64_tr_b16 v[172:173], v12 offset:8192
  ds_read_b64_tr_b16 v[174:175], v12 offset:8704
  v_mfma_f32_16x16x32_bf16 v[112:115], v[144:147], v[188:191], v[112:115]
  v_mfma_f32_16x16x32_bf16 v[116:119], v[148:151], v[188:191], v[116:119]
  v_mfma_f32_16x16x32_bf16 v[120:123], v[152:155], v[188:191], v[120:123]
  v_mfma_f32_16x16x32_bf16 v[124:127], v[156:159], v[188:191], v[124:127]
  ds_read_b128 v[144:147], v8 offset:0
  ds_read_b128 v[148:151], v8 offset:2048
  ds_read_b128 v[152:155], v8 offset:4096
  ds_read_b128 v[156:159], v8 offset:6144
  s_waitcnt lgkmcnt(4)
  ds_read_b64_tr_b16 v[176:177], v11 offset:4096
  ds_read_b64_tr_b16 v[178:179], v11 offset:4608
  v_mfma_f32_16x16x32_bf16 v[64:67], v[128:131], v[160:163], v[64:67]
  v_mfma_f32_16x16x32_bf16 v[68:71], v[132:135], v[160:163], v[68:71]
  v_mfma_f32_16x16x32_bf16 v[72:75], v[136:139], v[160:163], v[72:75]
  v_mfma_f32_16x16x32_bf16 v[76:79], v[140:143], v[160:163], v[76:79]
  ds_read_b64_tr_b16 v[180:181], v12 offset:4096
  ds_read_b64_tr_b16 v[182:183], v12 offset:4608
  v_mfma_f32_16x16x32_bf16 v[80:83], v[128:131], v[164:167], v[80:83]
  v_mfma_f32_16x16x32_bf16 v[84:87], v[132:135], v[164:167], v[84:87]
  v_mfma_f32_16x16x32_bf16 v[88:91], v[136:139], v[164:167], v[88:91]
  v_mfma_f32_16x16x32_bf16 v[92:95], v[140:143], v[164:167], v[92:95]
  ds_read_b64_tr_b16 v[184:185], v11 offset:12288
  ds_read_b64_tr_b16 v[186:187], v11 offset:12800
  v_mfma_f32_16x16x32_bf16 v[96:99], v[128:131], v[168:171], v[96:99]
  v_mfma_f32_16x16x32_bf16 v[100:103], v[132:135], v[168:171], v[100:103]
  v_mfma_f32_16x16x32_bf16 v[104:107], v[136:139], v[168:171], v[104:107]
  v_mfma_f32_16x16x32_bf16 v[108:111], v[140:143], v[168:171], v[108:111]
  ds_read_b64_tr_b16 v[188:189], v12 offset:12288
  ds_read_b64_tr_b16 v[190:191], v12 offset:12800
  v_mfma_f32_16x16x32_bf16 v[112:115], v[128:131], v[172:175], v[112:115]
  v_mfma_f32_16x16x32_bf16 v[116:119], v[132:135], v[172:175], v[116:119]
  v_mfma_f32_16x16x32_bf16 v[120:123], v[136:139], v[172:175], v[120:123]
  v_mfma_f32_16x16x32_bf16 v[124:127], v[140:143], v[172:175], v[124:127]
  s_waitcnt lgkmcnt(0)
  v_mfma_f32_16x16x32_bf16 v[64:67], v[144:147], v[176:179], v[64:67]
  v_lshl_or_b32 v32, v40, 16, v32
  v_lshl_or_b32 v33, v41, 16, v33
  v_mfma_f32_16x16x32_bf16 v[68:71], v[148:151], v[176:179], v[68:71]
  v_lshl_or_b32 v34, v42, 16, v34
  v_lshl_or_b32 v35, v43, 16, v35
  v_mfma_f32_16x16x32_bf16 v[72:75], v[152:155], v[176:179], v[72:75]
  v_lshl_or_b32 v36, v44, 16, v36
  v_lshl_or_b32 v37, v45, 16, v37
  v_mfma_f32_16x16x32_bf16 v[76:79], v[156:159], v[176:179], v[76:79]
  v_lshl_or_b32 v38, v46, 16, v38
  v_lshl_or_b32 v39, v47, 16, v39
  v_mfma_f32_16x16x32_bf16 v[80:83], v[144:147], v[180:183], v[80:83]
  buffer_store_dwordx4 v[32:35], v19, s[44:47], 0 offen
  buffer_store_dwordx4 v[36:39], v19, s[44:47], 0 offen offset:16
  v_mfma_f32_16x16x32_bf16 v[84:87], v[148:151], v[180:183], v[84:87]
  v_mfma_f32_16x16x32_bf16 v[88:91], v[152:155], v[180:183], v[88:91]
  v_mfma_f32_16x16x32_bf16 v[92:95], v[156:159], v[180:183], v[92:95]
  v_mfma_f32_16x16x32_bf16 v[96:99], v[144:147], v[184:187], v[96:99]
  v_mfma_f32_16x16x32_bf16 v[100:103], v[148:151], v[184:187], v[100:103]
  v_mfma_f32_16x16x32_bf16 v[104:107], v[152:155], v[184:187], v[104:107]
  v_mfma_f32_16x16x32_bf16 v[108:111], v[156:159], v[184:187], v[108:111]
  v_mfma_f32_16x16x32_bf16 v[112:115], v[144:147], v[188:191], v[112:115]
  v_mfma_f32_16x16x32_bf16 v[116:119], v[148:151], v[188:191], v[116:119]
  v_mfma_f32_16x16x32_bf16 v[120:123], v[152:155], v[188:191], v[120:123]
  v_mfma_f32_16x16x32_bf16 v[124:127], v[156:159], v[188:191], v[124:127]
  s_nop 7
  s_nop 7
  s_barrier
  s_mul_i32 s61, s58, 17408
  v_and_b32 v14, 15, v1
  v_mul_u32_u24 v14, 272, v14
  v_lshrrev_b32 v15, 4, v1
  v_lshl_add_u32 v14, v15, 4, v14
  v_add_u32 v14, s61, v14
  ds_write_b128 v14, v[64:67] offset:0
  ds_write_b128 v14, v[68:71] offset:64
  ds_write_b128 v14, v[72:75] offset:128
  ds_write_b128 v14, v[76:79] offset:192
  ds_write_b128 v14, v[80:83] offset:4352
  ds_write_b128 v14, v[84:87] offset:4416
  ds_write_b128 v14, v[88:91] offset:4480
  ds_write_b128 v14, v[92:95] offset:4544
  ds_write_b128 v14, v[96:99] offset:8704
  ds_write_b128 v14, v[100:103] offset:8768
  ds_write_b128 v14, v[104:107] offset:8832
  ds_write_b128 v14, v[108:111] offset:8896
  ds_write_b128 v14, v[112:115] offset:13056
  ds_write_b128 v14, v[116:119] offset:13120
  ds_write_b128 v14, v[120:123] offset:13184
  ds_write_b128 v14, v[124:127] offset:13248
  v_mul_u32_u24 v13, 272, v15
  v_and_b32 v14, 15, v1
  v_lshl_add_u32 v13, v14, 4, v13
  v_add_u32 v13, s61, v13
  s_waitcnt lgkmcnt(0)
  ds_read_b128 v[64:67], v13 offset:0
  ds_read_b128 v[68:71], v13 offset:1088
  ds_read_b128 v[72:75], v13 offset:2176
  ds_read_b128 v[76:79], v13 offset:3264
  ds_read_b128 v[80:83], v13 offset:4352
  ds_read_b128 v[84:87], v13 offset:5440
  ds_read_b128 v[88:91], v13 offset:6528
  ds_read_b128 v[92:95], v13 offset:7616
  ds_read_b128 v[96:99], v13 offset:8704
  ds_read_b128 v[100:103], v13 offset:9792
  ds_read_b128 v[104:107], v13 offset:10880
  ds_read_b128 v[108:111], v13 offset:11968
  ds_read_b128 v[112:115], v13 offset:13056
  ds_read_b128 v[116:119], v13 offset:14144
  ds_read_b128 v[120:123], v13 offset:15232
  ds_read_b128 v[124:127], v13 offset:16320
  s_lshl_b32 s61, s56, 7
  s_and_b32 s62, s58, 1
  s_lshl_b32 s62, s62, 5
  s_add_u32 s61, s61, s62
  v_add_u32 v15, s61, v15
  v_lshlrev_b32 v15, 13, v15
  v_lshl_add_u32 v15, v14, 4, v15
  s_lshl_b32 s61, s57, 10
  s_lshr_b32 s62, s58, 1
  s_lshl_b32 s62, s62, 8
  s_add_u32 s61, s61, s62
  v_add_u32 v15, s61, v15
  s_mov_b32 s61, 0
  s_waitcnt lgkmcnt(15)
  buffer_store_dwordx4 v[64:67], v15, s[32:35], s61 offen
  s_mov_b32 s61, 32768
  s_waitcnt lgkmcnt(14)
  buffer_store_dwordx4 v[68:71], v15, s[32:35], s61 offen
  s_mov_b32 s61, 65536
  s_waitcnt lgkmcnt(13)
  buffer_store_dwordx4 v[72:75], v15, s[32:35], s61 offen
  s_mov_b32 s61, 98304
  s_waitcnt lgkmcnt(12)
  buffer_store_dwordx4 v[76:79], v15, s[32:35], s61 offen
  s_mov_b32 s61, 131072
  s_waitcnt lgkmcnt(11)
  buffer_store_dwordx4 v[80:83], v15, s[32:35], s61 offen
  s_mov_b32 s61, 163840
  s_waitcnt lgkmcnt(10)
  buffer_store_dwordx4 v[84:87], v15, s[32:35], s61 offen
  s_mov_b32 s61, 196608
  s_waitcnt lgkmcnt(9)
  buffer_store_dwordx4 v[88:91], v15, s[32:35], s61 offen
  s_mov_b32 s61, 229376
  s_waitcnt lgkmcnt(8)
  buffer_store_dwordx4 v[92:95], v15, s[32:35], s61 offen
  s_mov_b32 s61, 524288
  s_waitcnt lgkmcnt(7)
  buffer_store_dwordx4 v[96:99], v15, s[32:35], s61 offen
  s_mov_b32 s61, 557056
  s_waitcnt lgkmcnt(6)
  buffer_store_dwordx4 v[100:103], v15, s[32:35], s61 offen
  s_mov_b32 s61, 589824
  s_waitcnt lgkmcnt(5)
  buffer_store_dwordx4 v[104:107], v15, s[32:35], s61 offen
  s_mov_b32 s61, 622592
  s_waitcnt lgkmcnt(4)
  buffer_store_dwordx4 v[108:111], v15, s[32:35], s61 offen
  s_mov_b32 s61, 655360
  s_waitcnt lgkmcnt(3)
  buffer_store_dwordx4 v[112:115], v15, s[32:35], s61 offen
  s_mov_b32 s61, 688128
  s_waitcnt lgkmcnt(2)
  buffer_store_dwordx4 v[116:119], v15, s[32:35], s61 offen
  s_mov_b32 s61, 720896
  s_waitcnt lgkmcnt(1)
  buffer_store_dwordx4 v[120:123], v15, s[32:35], s61 offen
  s_mov_b32 s61, 753664
  s_waitcnt lgkmcnt(0)
  buffer_store_dwordx4 v[124:127], v15, s[32:35], s61 offen
K1_END:
  s_endpgm
.section .rodata,"a"
.p2align 6
.amdhsa_kernel k1_kernel
  .amdhsa_next_free_vgpr 224
  .amdhsa_next_free_sgpr 102
  .amdhsa_accum_offset 224
  .amdhsa_group_segment_fixed_size 0
  .amdhsa_kernarg_size 88
  .amdhsa_user_sgpr_count 2
  .amdhsa_user_sgpr_kernarg_segment_ptr 1
  .amdhsa_system_sgpr_workgroup_id_x 1
  .amdhsa_float_denorm_mode_32 3
.end_amdhsa_kernel
.text
.globl k2_kernel
.p2align 8
.type k2_kernel,@function
k2_kernel:
  s_cmp_ge_u32 s2, 449
  s_cbranch_scc1 K2_END
  s_load_dwordx2 s[4:5], s[0:1], 80
  s_load_dwordx2 s[6:7], s[0:1], 48
  s_load_dwordx2 s[40:41], s[0:1], 72
  s_load_dwordx2 s[42:43], s[0:1], 64
  v_lshrrev_b32 v1, 6, v0
  s_nop 0
  v_readfirstlane_b32 s8, v1
  s_cmp_ge_u32 s2, 225
  s_cbranch_scc1 K2_F2
  s_setprio 3
  s_mov_b32 s11, s2
  s_getpc_b64 s[34:35]
  s_add_u32 s34, s34, tblTW@rel32@lo+4
  s_addc_u32 s35, s35, tblTW@rel32@hi+12
  s_waitcnt lgkmcnt(0)
  s_add_u32 s12, s4, 8388608
  s_addc_u32 s13, s5, 0
  s_and_b32 s13, s13, 0xffff
  s_mov_b32 s14, 3670016
  s_mov_b32 s15, 0x00020000
  s_add_u32 s16, s4, 12582912
  s_addc_u32 s17, s5, 0
  s_and_b32 s17, s17, 0xffff
  s_mov_b32 s18, 1843200
  s_mov_b32 s19, 0x00020000
  s_add_u32 s20, s4, 15728640
  s_addc_u32 s21, s5, 0
  s_and_b32 s21, s21, 0xffff
  s_mov_b32 s22, 1835008
  s_mov_b32 s23, 0x00020000
  s_mov_b32 s24, s34
  s_and_b32 s25, s35, 0xffff
  s_mov_b32 s26, 2336
  s_mov_b32 s27, 0x00020000
  s_mov_b32 s32, 0x3f3504f3
  s_mov_b32 s33, 0x3f3504f3
  s_lshl_b32 s28, s11, 13
  s_add_u32 s29, s28, 1835008
  s_lshl_b32 s30, s11, 12
  s_add_u32 s31, s30, 917504
  s_cmp_eq_u32 s11, 0
  s_cselect_b32 s29, 0x7f000000, s29
  s_cselect_b32 s31, 0x7f000000, s31
  s_cmp_eq_u32 s11, 224
  s_cselect_b32 s29, 0x7f000000, s29
  s_cselect_b32 s31, 0x7f000000, s31
  v_lshlrev_b32 v4, 3, v0
  buffer_load_dwordx2 v[64:65], v4, s[24:27], 0 offen
  v_and_b32 v11, 31, v0
  v_lshlrev_b32 v11, 3, v11
  buffer_load_dwordx2 v[78:79], v11, s[24:27], 0 offen offset:2048
  v_and_b32 v12, 3, v0
  v_lshlrev_b32 v12, 3, v12
  buffer_load_dwordx2 v[92:93], v12, s[24:27], 0 offen offset:2304
  v_lshlrev_b32 v2, 2, v0
  v_add_u32 v13, 4096, v2
  buffer_load_dword v16, v2, s[12:15], s28 offen offset:0
  buffer_load_dword v17, v2, s[12:15], s29 offen offset:0
  buffer_load_dword v18, v2, s[12:15], s28 offen offset:1024
  buffer_load_dword v19, v2, s[12:15], s29 offen offset:1024
  buffer_load_dword v20, v2, s[12:15], s28 offen offset:2048
  buffer_load_dword v21, v2, s[12:15], s29 offen offset:2048
  buffer_load_dword v22, v2, s[12:15], s28 offen offset:3072
  buffer_load_dword v23, v2, s[12:15], s29 offen offset:3072
  buffer_load_dword v24, v13, s[12:15], s28 offen offset:0
  buffer_load_dword v25, v13, s[12:15], s29 offen offset:0
  buffer_load_dword v26, v13, s[12:15], s28 offen offset:1024
  buffer_load_dword v27, v13, s[12:15], s29 offen offset:1024
  buffer_load_dword v28, v13, s[12:15], s28 offen offset:2048
  buffer_load_dword v29, v13, s[12:15], s29 offen offset:2048
  buffer_load_dword v30, v13, s[12:15], s28 offen offset:3072
  buffer_load_dword v31, v13, s[12:15], s29 offen offset:3072
  v_lshlrev_b32 v11, 5, v0
  s_lshl_b32 s9, s11, 13
  buffer_load_dwordx4 v[112:115], v11, s[16:19], s9 offen
  buffer_load_dwordx4 v[116:119], v11, s[16:19], s9 offen offset:16
  v_mov_b32 v5, v4
  v_lshrrev_b32 v11, 5, v0
  v_and_b32 v12, 31, v0
  v_lshlrev_b32 v6, 11, v11
  v_lshl_add_u32 v6, v12, 3, v6
  v_mul_u32_u24 v11, 2304, v11
  v_add_u32 v11, 32768, v11
  v_lshl_add_u32 v7, v12, 3, v11
  v_bfe_u32 v12, v0, 2, 3
  v_mul_u32_u24 v8, 288, v12
  v_add_u32 v8, v8, v11
  v_mul_u32_u24 v9, 272, v12
  v_add_u32 v9, v9, v11
  v_and_b32 v12, 3, v0
  v_lshl_add_u32 v8, v12, 3, v8
  v_lshl_add_u32 v10, v12, 6, v9
  v_lshl_add_u32 v9, v12, 3, v9
  v_lshlrev_b32 v3, 1, v0
  s_waitcnt vmcnt(18)
  v_mul_f32 v48, v64, v64
  v_mul_f32 v49, v65, v64
  v_fma_f32 v66, -v65, v65, v48
  v_fma_f32 v67, v64, v65, v49
  v_mul_f32 v48, v66, v64
  v_mul_f32 v49, v67, v64
  v_fma_f32 v68, -v67, v65, v48
  v_fma_f32 v69, v66, v65, v49
  v_mul_f32 v48, v66, v66
  v_mul_f32 v49, v67, v66
  v_fma_f32 v70, -v67, v67, v48
  v_fma_f32 v71, v66, v67, v49
  v_mul_f32 v48, v70, v64
  v_mul_f32 v49, v71, v64
  v_fma_f32 v72, -v71, v65, v48
  v_fma_f32 v73, v70, v65, v49
  v_mul_f32 v48, v68, v68
  v_mul_f32 v49, v69, v68
  v_fma_f32 v74, -v69, v69, v48
  v_fma_f32 v75, v68, v69, v49
  v_mul_f32 v48, v70, v68
  v_mul_f32 v49, v71, v68
  v_fma_f32 v76, -v71, v69, v48
  v_fma_f32 v77, v70, v69, v49
  v_mul_f32 v48, v78, v78
  v_mul_f32 v49, v79, v78
  v_fma_f32 v80, -v79, v79, v48
  v_fma_f32 v81, v78, v79, v49
  v_mul_f32 v48, v80, v78
  v_mul_f32 v49, v81, v78
  v_fma_f32 v82, -v81, v79, v48
  v_fma_f32 v83, v80, v79, v49
  v_mul_f32 v48, v80, v80
  v_mul_f32 v49, v81, v80
  v_fma_f32 v84, -v81, v81, v48
  v_fma_f32 v85, v80, v81, v49
  v_mul_f32 v48, v84, v78
  v_mul_f32 v49, v85, v78
  v_fma_f32 v86, -v85, v79, v48
  v_fma_f32 v87, v84, v79, v49
  v_mul_f32 v48, v82, v82
  v_mul_f32 v49, v83, v82
  v_fma_f32 v88, -v83, v83, v48
  v_fma_f32 v89, v82, v83, v49
  v_mul_f32 v48, v84, v82
  v_mul_f32 v49, v85, v82
  v_fma_f32 v90, -v85, v83, v48
  v_fma_f32 v91, v84, v83, v49
  v_mul_f32 v48, v92, v92
  v_mul_f32 v49, v93, v92
  v_fma_f32 v94, -v93, v93, v48
  v_fma_f32 v95, v92, v93, v49
  v_mul_f32 v48, v94, v92
  v_mul_f32 v49, v95, v92
  v_fma_f32 v96, -v95, v93, v48
  v_fma_f32 v97, v94, v93, v49
  v_mul_f32 v48, v94, v94
  v_mul_f32 v49, v95, v94
  v_fma_f32 v98, -v95, v95, v48
  v_fma_f32 v99, v94, v95, v49
  v_mul_f32 v48, v98, v92
  v_mul_f32 v49, v99, v92
  v_fma_f32 v100, -v99, v93, v48
  v_fma_f32 v101, v98, v93, v49
  v_mul_f32 v48, v96, v96
  v_mul_f32 v49, v97, v96
  v_fma_f32 v102, -v97, v97, v48
  v_fma_f32 v103, v96, v97, v49
  v_mul_f32 v48, v98, v96
  v_mul_f32 v49, v99, v96
  v_fma_f32 v104, -v99, v97, v48
  v_fma_f32 v105, v98, v97, v49
  s_waitcnt vmcnt(2)
  v_add_f32 v32, v16, v24
  v_add_f32 v33, v17, v25
  v_add_f32 v34, v18, v26
  v_add_f32 v35, v19, v27
  v_add_f32 v36, v20, v28
  v_add_f32 v37, v21, v29
  v_add_f32 v38, v22, v30
  v_add_f32 v39, v23, v31
  v_sub_f32 v40, v16, v24
  v_sub_f32 v41, v17, v25
  v_sub_f32 v42, v18, v26
  v_sub_f32 v43, v19, v27
  v_sub_f32 v44, v20, v28
  v_sub_f32 v45, v21, v29
  v_sub_f32 v46, v22, v30
  v_sub_f32 v47, v23, v31
  v_add_f32 v16, v32, v36
  v_add_f32 v17, v33, v37
  v_add_f32 v18, v34, v38
  v_add_f32 v19, v35, v39
  v_sub_f32 v20, v32, v36
  v_sub_f32 v21, v33, v37
  v_sub_f32 v22, v34, v38
  v_sub_f32 v23, v35, v39
  v_add_f32 v24, v42, v43
  v_sub_f32 v25, v43, v42
  v_add_f32 v26, v46, v47
  v_sub_f32 v27, v47, v46
  v_add_f32 v28, v40, v45
  v_sub_f32 v29, v41, v44
  v_sub_f32 v30, v40, v45
  v_add_f32 v31, v41, v44
  v_add_f32 v48, v24, v27
  v_sub_f32 v49, v25, v26
  v_sub_f32 v50, v24, v27
  v_add_f32 v51, v25, v26
  v_add_f32 v32, v16, v18
  v_add_f32 v33, v17, v19
  v_sub_f32 v40, v16, v18
  v_sub_f32 v41, v17, v19
  v_add_f32 v36, v20, v23
  v_sub_f32 v37, v21, v22
  v_sub_f32 v44, v20, v23
  v_add_f32 v45, v21, v22
  v_fma_f32 v34, v48, s32, v28
  v_fma_f32 v35, v49, s32, v29
  v_fma_f32 v42, -v48, s32, v28
  v_fma_f32 v43, -v49, s32, v29
  v_fma_f32 v38, v51, s32, v30
  v_fma_f32 v39, -v50, s32, v31
  v_fma_f32 v46, -v51, s32, v30
  v_fma_f32 v47, v50, s32, v31
  v_mov_b32 v16, v32
  v_mov_b32 v17, v33
  v_mul_f32 v18, v34, v64
  v_mul_f32 v19, v35, v64
  v_mul_f32 v20, v36, v66
  v_mul_f32 v21, v37, v66
  v_mul_f32 v22, v38, v68
  v_mul_f32 v23, v39, v68
  v_mul_f32 v24, v40, v70
  v_mul_f32 v25, v41, v70
  v_mul_f32 v26, v42, v72
  v_mul_f32 v27, v43, v72
  v_mul_f32 v28, v44, v74
  v_mul_f32 v29, v45, v74
  v_mul_f32 v30, v46, v76
  v_mul_f32 v31, v47, v76
  v_fma_f32 v18, -v35, v65, v18
  v_fma_f32 v19, v34, v65, v19
  v_fma_f32 v20, -v37, v67, v20
  v_fma_f32 v21, v36, v67, v21
  v_fma_f32 v22, -v39, v69, v22
  v_fma_f32 v23, v38, v69, v23
  v_fma_f32 v24, -v41, v71, v24
  v_fma_f32 v25, v40, v71, v25
  v_fma_f32 v26, -v43, v73, v26
  v_fma_f32 v27, v42, v73, v27
  v_fma_f32 v28, -v45, v75, v28
  v_fma_f32 v29, v44, v75, v29
  v_fma_f32 v30, -v47, v77, v30
  v_fma_f32 v31, v46, v77, v31
  ds_write_b64 v5, v[16:17] offset:0
  ds_write_b64 v5, v[18:19] offset:2048
  ds_write_b64 v5, v[20:21] offset:4096
  ds_write_b64 v5, v[22:23] offset:6144
  ds_write_b64 v5, v[24:25] offset:8192
  ds_write_b64 v5, v[26:27] offset:10240
  ds_write_b64 v5, v[28:29] offset:12288
  ds_write_b64 v5, v[30:31] offset:14336
  s_waitcnt lgkmcnt(0)
  s_barrier
  ds_read_b64 v[16:17], v6 offset:0
  ds_read_b64 v[18:19], v6 offset:256
  ds_read_b64 v[20:21], v6 offset:512
  ds_read_b64 v[22:23], v6 offset:768
  ds_read_b64 v[24:25], v6 offset:1024
  ds_read_b64 v[26:27], v6 offset:1280
  ds_read_b64 v[28:29], v6 offset:1536
  ds_read_b64 v[30:31], v6 offset:1792
  s_waitcnt lgkmcnt(0)
  v_add_f32 v32, v16, v24
  v_add_f32 v33, v17, v25
  v_add_f32 v34, v18, v26
  v_add_f32 v35, v19, v27
  v_add_f32 v36, v20, v28
  v_add_f32 v37, v21, v29
  v_add_f32 v38, v22, v30
  v_add_f32 v39, v23, v31
  v_sub_f32 v40, v16, v24
  v_sub_f32 v41, v17, v25
  v_sub_f32 v42, v18, v26
  v_sub_f32 v43, v19, v27
  v_sub_f32 v44, v20, v28
  v_sub_f32 v45, v21, v29
  v_sub_f32 v46, v22, v30
  v_sub_f32 v47, v23, v31
  v_add_f32 v16, v32, v36
  v_add_f32 v17, v33, v37
  v_add_f32 v18, v34, v38
  v_add_f32 v19, v35, v39
  v_sub_f32 v20, v32, v36
  v_sub_f32 v21, v33, v37
  v_sub_f32 v22, v34, v38
  v_sub_f32 v23, v35, v39
  v_add_f32 v24, v42, v43
  v_sub_f32 v25, v43, v42
  v_add_f32 v26, v46, v47
  v_sub_f32 v27, v47, v46
  v_add_f32 v28, v40, v45
  v_sub_f32 v29, v41, v44
  v_sub_f32 v30, v40, v45
  v_add_f32 v31, v41, v44
  v_add_f32 v48, v24, v27
  v_sub_f32 v49, v25, v26
  v_sub_f32 v50, v24, v27
  v_add_f32 v51, v25, v26
  v_add_f32 v32, v16, v18
  v_add_f32 v33, v17, v19
  v_sub_f32 v40, v16, v18
  v_sub_f32 v41, v17, v19
  v_add_f32 v36, v20, v23
  v_sub_f32 v37, v21, v22
  v_sub_f32 v44, v20, v23
  v_add_f32 v45, v21, v22
  v_fma_f32 v34, v48, s32, v28
  v_fma_f32 v35, v49, s32, v29
  v_fma_f32 v42, -v48, s32, v28
  v_fma_f32 v43, -v49, s32, v29
  v_fma_f32 v38, v51, s32, v30
  v_fma_f32 v39, -v50, s32, v31
  v_fma_f32 v46, -v51, s32, v30
  v_fma_f32 v47, v50, s32, v31
  v_mov_b32 v16, v32
  v_mov_b32 v17, v33
  v_mul_f32 v18, v34, v78
  v_mul_f32 v19, v35, v78
  v_mul_f32 v20, v36, v80
  v_mul_f32 v21, v37, v80
  v_mul_f32 v22, v38, v82
  v_mul_f32 v23, v39, v82
  v_mul_f32 v24, v40, v84
  v_mul_f32 v25, v41, v84
  v_mul_f32 v26, v42, v86
  v_mul_f32 v27, v43, v86
  v_mul_f32 v28, v44, v88
  v_mul_f32 v29, v45, v88
  v_mul_f32 v30, v46, v90
  v_mul_f32 v31, v47, v90
  v_fma_f32 v18, -v35, v79, v18
  v_fma_f32 v19, v34, v79, v19
  v_fma_f32 v20, -v37, v81, v20
  v_fma_f32 v21, v36, v81, v21
  v_fma_f32 v22, -v39, v83, v22
  v_fma_f32 v23, v38, v83, v23
  v_fma_f32 v24, -v41, v85, v24
  v_fma_f32 v25, v40, v85, v25
  v_fma_f32 v26, -v43, v87, v26
  v_fma_f32 v27, v42, v87, v27
  v_fma_f32 v28, -v45, v89, v28
  v_fma_f32 v29, v44, v89, v29
  v_fma_f32 v30, -v47, v91, v30
  v_fma_f32 v31, v46, v91, v31
  ds_write_b64 v7, v[16:17] offset:0
  ds_write_b64 v7, v[18:19] offset:288
  ds_write_b64 v7, v[20:21] offset:576
  ds_write_b64 v7, v[22:23] offset:864
  ds_write_b64 v7, v[24:25] offset:1152
  ds_write_b64 v7, v[26:27] offset:1440
  ds_write_b64 v7, v[28:29] offset:1728
  ds_write_b64 v7, v[30:31] offset:2016
  ds_read_b64 v[16:17], v8 offset:0
  ds_read_b64 v[18:19], v8 offset:32
  ds_read_b64 v[20:21], v8 offset:64
  ds_read_b64 v[22:23], v8 offset:96
  ds_read_b64 v[24:25], v8 offset:128
  ds_read_b64 v[26:27], v8 offset:160
  ds_read_b64 v[28:29], v8 offset:192
  ds_read_b64 v[30:31], v8 offset:224
  s_waitcnt lgkmcnt(0)
  v_add_f32 v32, v16, v24
  v_add_f32 v33, v17, v25
  v_add_f32 v34, v18, v26
  v_add_f32 v35, v19, v27
  v_add_f32 v36, v20, v28
  v_add_f32 v37, v21, v29
  v_add_f32 v38, v22, v30
  v_add_f32 v39, v23, v31
  v_sub_f32 v40, v16, v24
  v_sub_f32 v41, v17, v25
  v_sub_f32 v42, v18, v26
  v_sub_f32 v43, v19, v27
  v_sub_f32 v44, v20, v28
  v_sub_f32 v45, v21, v29
  v_sub_f32 v46, v22, v30
  v_sub_f32 v47, v23, v31
  v_add_f32 v16, v32, v36
  v_add_f32 v17, v33, v37
  v_add_f32 v18, v34, v38
  v_add_f32 v19, v35, v39
  v_sub_f32 v20, v32, v36
  v_sub_f32 v21, v33, v37
  v_sub_f32 v22, v34, v38
  v_sub_f32 v23, v35, v39
  v_add_f32 v24, v42, v43
  v_sub_f32 v25, v43, v42
  v_add_f32 v26, v46, v47
  v_sub_f32 v27, v47, v46
  v_add_f32 v28, v40, v45
  v_sub_f32 v29, v41, v44
  v_sub_f32 v30, v40, v45
  v_add_f32 v31, v41, v44
  v_add_f32 v48, v24, v27
  v_sub_f32 v49, v25, v26
  v_sub_f32 v50, v24, v27
  v_add_f32 v51, v25, v26
  v_add_f32 v32, v16, v18
  v_add_f32 v33, v17, v19
  v_sub_f32 v40, v16, v18
  v_sub_f32 v41, v17, v19
  v_add_f32 v36, v20, v23
  v_sub_f32 v37, v21, v22
  v_sub_f32 v44, v20, v23
  v_add_f32 v45, v21, v22
  v_fma_f32 v34, v48, s32, v28
  v_fma_f32 v35, v49, s32, v29
  v_fma_f32 v42, -v48, s32, v28
  v_fma_f32 v43, -v49, s32, v29
  v_fma_f32 v38, v51, s32, v30
  v_fma_f32 v39, -v50, s32, v31
  v_fma_f32 v46, -v51, s32, v30
  v_fma_f32 v47, v50, s32, v31
  v_mov_b32 v16, v32
  v_mov_b32 v17, v33
  v_mul_f32 v18, v34, v92
  v_mul_f32 v19, v35, v92
  v_mul_f32 v20, v36, v94
  v_mul_f32 v21, v37, v94
  v_mul_f32 v22, v38, v96
  v_mul_f32 v23, v39, v96
  v_mul_f32 v24, v40, v98
  v_mul_f32 v25, v41, v98
  v_mul_f32 v26, v42, v100
  v_mul_f32 v27, v43, v100
  v_mul_f32 v28, v44, v102
  v_mul_f32 v29, v45, v102
  v_mul_f32 v30, v46, v104
  v_mul_f32 v31, v47, v104
  v_fma_f32 v18, -v35, v93, v18
  v_fma_f32 v19, v34, v93, v19
  v_fma_f32 v20, -v37, v95, v20
  v_fma_f32 v21, v36, v95, v21
  v_fma_f32 v22, -v39, v97, v22
  v_fma_f32 v23, v38, v97, v23
  v_fma_f32 v24, -v41, v99, v24
  v_fma_f32 v25, v40, v99, v25
  v_fma_f32 v26, -v43, v101, v26
  v_fma_f32 v27, v42, v101, v27
  v_fma_f32 v28, -v45, v103, v28
  v_fma_f32 v29, v44, v103, v29
  v_fma_f32 v30, -v47, v105, v30
  v_fma_f32 v31, v46, v105, v31
  ds_write_b64 v9, v[16:17] offset:0
  ds_write_b64 v9, v[18:19] offset:32
  ds_write_b64 v9, v[20:21] offset:64
  ds_write_b64 v9, v[22:23] offset:96
  ds_write_b64 v9, v[24:25] offset:128
  ds_write_b64 v9, v[26:27] offset:160
  ds_write_b64 v9, v[28:29] offset:192
  ds_write_b64 v9, v[30:31] offset:224
  ds_read_b128 v[16:19], v10 offset:0
  ds_read_b128 v[20:23], v10 offset:16
  ds_read_b128 v[24:27], v10 offset:32
  ds_read_b128 v[28:31], v10 offset:48
  s_waitcnt lgkmcnt(0) vmcnt(0)
  v_add_f32 v32, v16, v20
  v_add_f32 v33, v17, v21
  v_add_f32 v34, v18, v22
  v_add_f32 v35, v19, v23
  v_sub_f32 v36, v16, v20
  v_sub_f32 v37, v17, v21
  v_sub_f32 v38, v18, v22
  v_sub_f32 v39, v19, v23
  v_add_f32 v16, v32, v34
  v_add_f32 v17, v33, v35
  v_sub_f32 v20, v32, v34
  v_sub_f32 v21, v33, v35
  v_add_f32 v18, v36, v39
  v_sub_f32 v19, v37, v38
  v_sub_f32 v22, v36, v39
  v_add_f32 v23, v37, v38
  v_add_f32 v40, v24, v28
  v_add_f32 v41, v25, v29
  v_add_f32 v42, v26, v30
  v_add_f32 v43, v27, v31
  v_sub_f32 v44, v24, v28
  v_sub_f32 v45, v25, v29
  v_sub_f32 v46, v26, v30
  v_sub_f32 v47, v27, v31
  v_add_f32 v24, v40, v42
  v_add_f32 v25, v41, v43
  v_sub_f32 v28, v40, v42
  v_sub_f32 v29, v41, v43
  v_add_f32 v26, v44, v47
  v_sub_f32 v27, v45, v46
  v_sub_f32 v30, v44, v47
  v_add_f32 v31, v45, v46
  v_lshlrev_b32 v120, 16, v112
  v_and_b32 v121, 0xffff0000, v112
  v_lshlrev_b32 v122, 16, v113
  v_and_b32 v123, 0xffff0000, v113
  v_lshlrev_b32 v124, 16, v114
  v_and_b32 v125, 0xffff0000, v114
  v_lshlrev_b32 v126, 16, v115
  v_and_b32 v127, 0xffff0000, v115
  v_lshlrev_b32 v128, 16, v116
  v_and_b32 v129, 0xffff0000, v116
  v_lshlrev_b32 v130, 16, v117
  v_and_b32 v131, 0xffff0000, v117
  v_lshlrev_b32 v132, 16, v118
  v_and_b32 v133, 0xffff0000, v118
  v_lshlrev_b32 v134, 16, v119
  v_and_b32 v135, 0xffff0000, v119
  v_mul_f32 v32, v16, v120
  v_mul_f32 v33, v17, v120
  v_mul_f32 v34, v18, v122
  v_mul_f32 v35, v19, v122
  v_mul_f32 v36, v20, v124
  v_mul_f32 v37, v21, v124
  v_mul_f32 v38, v22, v126
  v_mul_f32 v39, v23, v126
  v_mul_f32 v40, v24, v128
  v_mul_f32 v41, v25, v128
  v_mul_f32 v42, v26, v130
  v_mul_f32 v43, v27, v130
  v_mul_f32 v44, v28, v132
  v_mul_f32 v45, v29, v132
  v_mul_f32 v46, v30, v134
  v_mul_f32 v47, v31, v134
  v_fma_f32 v32, -v17, v121, v32
  v_fma_f32 v33, v16, v121, v33
  v_fma_f32 v34, -v19, v123, v34
  v_fma_f32 v35, v18, v123, v35
  v_fma_f32 v36, -v21, v125, v36
  v_fma_f32 v37, v20, v125, v37
  v_fma_f32 v38, -v23, v127, v38
  v_fma_f32 v39, v22, v127, v39
  v_fma_f32 v40, -v25, v129, v40
  v_fma_f32 v41, v24, v129, v41
  v_fma_f32 v42, -v27, v131, v42
  v_fma_f32 v43, v26, v131, v43
  v_fma_f32 v44, -v29, v133, v44
  v_fma_f32 v45, v28, v133, v45
  v_fma_f32 v46, -v31, v135, v46
  v_fma_f32 v47, v30, v135, v47
  v_add_f32 v16, v32, v36
  v_add_f32 v17, v33, v37
  v_add_f32 v18, v34, v38
  v_add_f32 v19, v35, v39
  v_sub_f32 v20, v32, v36
  v_sub_f32 v21, v33, v37
  v_sub_f32 v22, v34, v38
  v_sub_f32 v23, v35, v39
  v_add_f32 v32, v16, v18
  v_add_f32 v33, v17, v19
  v_sub_f32 v36, v16, v18
  v_sub_f32 v37, v17, v19
  v_sub_f32 v34, v20, v23
  v_add_f32 v35, v21, v22
  v_add_f32 v38, v20, v23
  v_sub_f32 v39, v21, v22
  v_add_f32 v24, v40, v44
  v_add_f32 v25, v41, v45
  v_add_f32 v26, v42, v46
  v_add_f32 v27, v43, v47
  v_sub_f32 v28, v40, v44
  v_sub_f32 v29, v41, v45
  v_sub_f32 v30, v42, v46
  v_sub_f32 v31, v43, v47
  v_add_f32 v40, v24, v26
  v_add_f32 v41, v25, v27
  v_sub_f32 v44, v24, v26
  v_sub_f32 v45, v25, v27
  v_sub_f32 v42, v28, v31
  v_add_f32 v43, v29, v30
  v_add_f32 v46, v28, v31
  v_sub_f32 v47, v29, v30
  ds_write_b128 v10, v[32:35] offset:0
  ds_write_b128 v10, v[36:39] offset:16
  ds_write_b128 v10, v[40:43] offset:32
  ds_write_b128 v10, v[44:47] offset:48
  ds_read_b64 v[32:33], v9 offset:0
  ds_read_b64 v[34:35], v9 offset:32
  ds_read_b64 v[36:37], v9 offset:64
  ds_read_b64 v[38:39], v9 offset:96
  ds_read_b64 v[40:41], v9 offset:128
  ds_read_b64 v[42:43], v9 offset:160
  ds_read_b64 v[44:45], v9 offset:192
  ds_read_b64 v[46:47], v9 offset:224
  s_waitcnt lgkmcnt(0)
  v_mov_b32 v16, v32
  v_mov_b32 v17, v33
  v_mul_f32 v18, v34, v92
  v_mul_f32 v19, v35, v92
  v_mul_f32 v20, v36, v94
  v_mul_f32 v21, v37, v94
  v_mul_f32 v22, v38, v96
  v_mul_f32 v23, v39, v96
  v_mul_f32 v24, v40, v98
  v_mul_f32 v25, v41, v98
  v_mul_f32 v26, v42, v100
  v_mul_f32 v27, v43, v100
  v_mul_f32 v28, v44, v102
  v_mul_f32 v29, v45, v102
  v_mul_f32 v30, v46, v104
  v_mul_f32 v31, v47, v104
  v_fma_f32 v18, v35, v93, v18
  v_fma_f32 v19, -v34, v93, v19
  v_fma_f32 v20, v37, v95, v20
  v_fma_f32 v21, -v36, v95, v21
  v_fma_f32 v22, v39, v97, v22
  v_fma_f32 v23, -v38, v97, v23
  v_fma_f32 v24, v41, v99, v24
  v_fma_f32 v25, -v40, v99, v25
  v_fma_f32 v26, v43, v101, v26
  v_fma_f32 v27, -v42, v101, v27
  v_fma_f32 v28, v45, v103, v28
  v_fma_f32 v29, -v44, v103, v29
  v_fma_f32 v30, v47, v105, v30
  v_fma_f32 v31, -v46, v105, v31
  v_add_f32 v32, v16, v24
  v_add_f32 v33, v17, v25
  v_add_f32 v34, v18, v26
  v_add_f32 v35, v19, v27
  v_add_f32 v36, v20, v28
  v_add_f32 v37, v21, v29
  v_add_f32 v38, v22, v30
  v_add_f32 v39, v23, v31
  v_sub_f32 v40, v16, v24
  v_sub_f32 v41, v17, v25
  v_sub_f32 v42, v18, v26
  v_sub_f32 v43, v19, v27
  v_sub_f32 v44, v20, v28
  v_sub_f32 v45, v21, v29
  v_sub_f32 v46, v22, v30
  v_sub_f32 v47, v23, v31
  v_add_f32 v16, v32, v36
  v_add_f32 v17, v33, v37
  v_add_f32 v18, v34, v38
  v_add_f32 v19, v35, v39
  v_sub_f32 v20, v32, v36
  v_sub_f32 v21, v33, v37
  v_sub_f32 v22, v34, v38
  v_sub_f32 v23, v35, v39
  v_sub_f32 v24, v42, v43
  v_add_f32 v25, v43, v42
  v_sub_f32 v26, v46, v47
  v_add_f32 v27, v47, v46
  v_sub_f32 v28, v40, v45
  v_add_f32 v29, v41, v44
  v_add_f32 v30, v40, v45
  v_sub_f32 v31, v41, v44
  v_sub_f32 v48, v24, v27
  v_add_f32 v49, v25, v26
  v_add_f32 v50, v24, v27
  v_sub_f32 v51, v25, v26
  v_add_f32 v32, v16, v18
  v_add_f32 v33, v17, v19
  v_sub_f32 v40, v16, v18
  v_sub_f32 v41, v17, v19
  v_sub_f32 v36, v20, v23
  v_add_f32 v37, v21, v22
  v_add_f32 v44, v20, v23
  v_sub_f32 v45, v21, v22
  v_fma_f32 v34, v48, s32, v28
  v_fma_f32 v35, v49, s32, v29
  v_fma_f32 v42, -v48, s32, v28
  v_fma_f32 v43, -v49, s32, v29
  v_fma_f32 v38, -v51, s32, v30
  v_fma_f32 v39, v50, s32, v31
  v_fma_f32 v46, v51, s32, v30
  v_fma_f32 v47, -v50, s32, v31
  ds_write_b64 v8, v[32:33] offset:0
  ds_write_b64 v8, v[34:35] offset:32
  ds_write_b64 v8, v[36:37] offset:64
  ds_write_b64 v8, v[38:39] offset:96
  ds_write_b64 v8, v[40:41] offset:128
  ds_write_b64 v8, v[42:43] offset:160
  ds_write_b64 v8, v[44:45] offset:192
  ds_write_b64 v8, v[46:47] offset:224
  ds_read_b64 v[32:33], v7 offset:0
  ds_read_b64 v[34:35], v7 offset:288
  ds_read_b64 v[36:37], v7 offset:576
  ds_read_b64 v[38:39], v7 offset:864
  ds_read_b64 v[40:41], v7 offset:1152
  ds_read_b64 v[42:43], v7 offset:1440
  ds_read_b64 v[44:45], v7 offset:1728
  ds_read_b64 v[46:47], v7 offset:2016
  s_waitcnt lgkmcnt(0)
  v_mov_b32 v16, v32
  v_mov_b32 v17, v33
  v_mul_f32 v18, v34, v78
  v_mul_f32 v19, v35, v78
  v_mul_f32 v20, v36, v80
  v_mul_f32 v21, v37, v80
  v_mul_f32 v22, v38, v82
  v_mul_f32 v23, v39, v82
  v_mul_f32 v24, v40, v84
  v_mul_f32 v25, v41, v84
  v_mul_f32 v26, v42, v86
  v_mul_f32 v27, v43, v86
  v_mul_f32 v28, v44, v88
  v_mul_f32 v29, v45, v88
  v_mul_f32 v30, v46, v90
  v_mul_f32 v31, v47, v90
  v_fma_f32 v18, v35, v79, v18
  v_fma_f32 v19, -v34, v79, v19
  v_fma_f32 v20, v37, v81, v20
  v_fma_f32 v21, -v36, v81, v21
  v_fma_f32 v22, v39, v83, v22
  v_fma_f32 v23, -v38, v83, v23
  v_fma_f32 v24, v41, v85, v24
  v_fma_f32 v25, -v40, v85, v25
  v_fma_f32 v26, v43, v87, v26
  v_fma_f32 v27, -v42, v87, v27
  v_fma_f32 v28, v45, v89, v28
  v_fma_f32 v29, -v44, v89, v29
  v_fma_f32 v30, v47, v91, v30
  v_fma_f32 v31, -v46, v91, v31
  v_add_f32 v32, v16, v24
  v_add_f32 v33, v17, v25
  v_add_f32 v34, v18, v26
  v_add_f32 v35, v19, v27
  v_add_f32 v36, v20, v28
  v_add_f32 v37, v21, v29
  v_add_f32 v38, v22, v30
  v_add_f32 v39, v23, v31
  v_sub_f32 v40, v16, v24
  v_sub_f32 v41, v17, v25
  v_sub_f32 v42, v18, v26
  v_sub_f32 v43, v19, v27
  v_sub_f32 v44, v20, v28
  v_sub_f32 v45, v21, v29
  v_sub_f32 v46, v22, v30
  v_sub_f32 v47, v23, v31
  v_add_f32 v16, v32, v36
  v_add_f32 v17, v33, v37
  v_add_f32 v18, v34, v38
  v_add_f32 v19, v35, v39
  v_sub_f32 v20, v32, v36
  v_sub_f32 v21, v33, v37
  v_sub_f32 v22, v34, v38
  v_sub_f32 v23, v35, v39
  v_sub_f32 v24, v42, v43
  v_add_f32 v25, v43, v42
  v_sub_f32 v26, v46, v47
  v_add_f32 v27, v47, v46
  v_sub_f32 v28, v40, v45
  v_add_f32 v29, v41, v44
  v_add_f32 v30, v40, v45
  v_sub_f32 v31, v41, v44
  v_sub_f32 v48, v24, v27
  v_add_f32 v49, v25, v26
  v_add_f32 v50, v24, v27
  v_sub_f32 v51, v25, v26
  v_add_f32 v32, v16, v18
  v_add_f32 v33, v17, v19
  v_sub_f32 v40, v16, v18
  v_sub_f32 v41, v17, v19
  v_sub_f32 v36, v20, v23
  v_add_f32 v37, v21, v22
  v_add_f32 v44, v20, v23
  v_sub_f32 v45, v21, v22
  v_fma_f32 v34, v48, s32, v28
  v_fma_f32 v35, v49, s32, v29
  v_fma_f32 v42, -v48, s32, v28
  v_fma_f32 v43, -v49, s32, v29
  v_fma_f32 v38, -v51, s32, v30
  v_fma_f32 v39, v50, s32, v31
  v_fma_f32 v46, v51, s32, v30
  v_fma_f32 v47, -v50, s32, v31
  ds_write_b64 v6, v[32:33] offset:16384
  ds_write_b64 v6, v[34:35] offset:16640
  ds_write_b64 v6, v[36:37] offset:16896
  ds_write_b64 v6, v[38:39] offset:17152
  ds_write_b64 v6, v[40:41] offset:17408
  ds_write_b64 v6, v[42:43] offset:17664
  ds_write_b64 v6, v[44:45] offset:17920
  ds_write_b64 v6, v[46:47] offset:18176
  s_waitcnt lgkmcnt(0)
  s_barrier
  ds_read_b64 v[32:33], v5 offset:16384
  ds_read_b64 v[34:35], v5 offset:18432
  ds_read_b64 v[36:37], v5 offset:20480
  ds_read_b64 v[38:39], v5 offset:22528
  ds_read_b64 v[40:41], v5 offset:24576
  ds_read_b64 v[42:43], v5 offset:26624
  ds_read_b64 v[44:45], v5 offset:28672
  ds_read_b64 v[46:47], v5 offset:30720
  s_waitcnt lgkmcnt(0)
  v_mov_b32 v16, v32
  v_mov_b32 v17, v33
  v_mul_f32 v18, v34, v64
  v_mul_f32 v19, v35, v64
  v_mul_f32 v20, v36, v66
  v_mul_f32 v21, v37, v66
  v_mul_f32 v22, v38, v68
  v_mul_f32 v23, v39, v68
  v_mul_f32 v24, v40, v70
  v_mul_f32 v25, v41, v70
  v_mul_f32 v26, v42, v72
  v_mul_f32 v27, v43, v72
  v_mul_f32 v28, v44, v74
  v_mul_f32 v29, v45, v74
  v_mul_f32 v30, v46, v76
  v_mul_f32 v31, v47, v76
  v_fma_f32 v18, v35, v65, v18
  v_fma_f32 v19, -v34, v65, v19
  v_fma_f32 v20, v37, v67, v20
  v_fma_f32 v21, -v36, v67, v21
  v_fma_f32 v22, v39, v69, v22
  v_fma_f32 v23, -v38, v69, v23
  v_fma_f32 v24, v41, v71, v24
  v_fma_f32 v25, -v40, v71, v25
  v_fma_f32 v26, v43, v73, v26
  v_fma_f32 v27, -v42, v73, v27
  v_fma_f32 v28, v45, v75, v28
  v_fma_f32 v29, -v44, v75, v29
  v_fma_f32 v30, v47, v77, v30
  v_fma_f32 v31, -v46, v77, v31
  v_add_f32 v32, v16, v24
  v_add_f32 v33, v17, v25
  v_add_f32 v34, v18, v26
  v_add_f32 v35, v19, v27
  v_add_f32 v36, v20, v28
  v_add_f32 v37, v21, v29
  v_add_f32 v38, v22, v30
  v_add_f32 v39, v23, v31
  v_sub_f32 v40, v16, v24
  v_sub_f32 v41, v17, v25
  v_sub_f32 v42, v18, v26
  v_sub_f32 v43, v19, v27
  v_sub_f32 v44, v20, v28
  v_sub_f32 v45, v21, v29
  v_sub_f32 v46, v22, v30
  v_sub_f32 v47, v23, v31
  v_add_f32 v16, v32, v36
  v_add_f32 v17, v33, v37
  v_add_f32 v18, v34, v38
  v_add_f32 v19, v35, v39
  v_sub_f32 v20, v32, v36
  v_sub_f32 v21, v33, v37
  v_sub_f32 v22, v34, v38
  v_sub_f32 v23, v35, v39
  v_sub_f32 v24, v42, v43
  v_add_f32 v25, v43, v42
  v_sub_f32 v26, v46, v47
  v_add_f32 v27, v47, v46
  v_sub_f32 v28, v40, v45
  v_add_f32 v29, v41, v44
  v_add_f32 v30, v40, v45
  v_sub_f32 v31, v41, v44
  v_sub_f32 v48, v24, v27
  v_add_f32 v49, v25, v26
  v_add_f32 v50, v24, v27
  v_sub_f32 v51, v25, v26
  v_add_f32 v32, v16, v18
  v_add_f32 v33, v17, v19
  v_sub_f32 v40, v16, v18
  v_sub_f32 v41, v17, v19
  v_sub_f32 v36, v20, v23
  v_add_f32 v37, v21, v22
  v_add_f32 v44, v20, v23
  v_sub_f32 v45, v21, v22
  v_fma_f32 v34, v48, s32, v28
  v_fma_f32 v35, v49, s32, v29
  v_fma_f32 v42, -v48, s32, v28
  v_fma_f32 v43, -v49, s32, v29
  v_fma_f32 v38, -v51, s32, v30
  v_fma_f32 v39, v50, s32, v31
  v_fma_f32 v46, v51, s32, v30
  v_fma_f32 v47, -v50, s32, v31
  v_cvt_pk_bf16_f32 v16, v32, v33
  v_cvt_pk_bf16_f32 v17, v34, v35
  v_cvt_pk_bf16_f32 v18, v36, v37
  v_cvt_pk_bf16_f32 v19, v38, v39
  v_cvt_pk_bf16_f32 v20, v40, v41
  v_cvt_pk_bf16_f32 v21, v42, v43
  v_cvt_pk_bf16_f32 v22, v44, v45
  v_cvt_pk_bf16_f32 v23, v46, v47
  ds_write_b32 v2, v16 offset:0
  ds_write_b32 v2, v17 offset:1024
  ds_write_b32 v2, v18 offset:2048
  ds_write_b32 v2, v19 offset:3072
  ds_write_b32 v2, v20 offset:4096
  ds_write_b32 v2, v21 offset:5120
  ds_write_b32 v2, v22 offset:6144
  ds_write_b32 v2, v23 offset:7168
  s_waitcnt lgkmcnt(0)
  s_barrier
  v_lshlrev_b32 v11, 5, v0
  ds_read_b128 v[32:35], v11 offset:0
  ds_read_b128 v[36:39], v11 offset:16
  s_mov_b32 s9, 0x05040100
  s_mov_b32 s10, 0x07060302
  v_lshlrev_b32 v12, 4, v0
  s_waitcnt lgkmcnt(0)
  v_perm_b32 v16, v33, v32, s9
  v_perm_b32 v20, v33, v32, s10
  v_perm_b32 v17, v35, v34, s9
  v_perm_b32 v21, v35, v34, s10
  v_perm_b32 v18, v37, v36, s9
  v_perm_b32 v22, v37, v36, s10
  v_perm_b32 v19, v39, v38, s9
  v_perm_b32 v23, v39, v38, s10
  buffer_store_dwordx4 v[16:19], v12, s[20:23], s30 offen sc1
  buffer_store_dwordx4 v[20:23], v12, s[20:23], s31 offen sc1
  s_waitcnt vmcnt(0)
  s_barrier
K2_FFT_SIG:
  s_cmp_lg_u32 s8, 0
  s_cbranch_scc1 K2_FFT_END
  s_add_u32 s12, s4, 19922944
  s_addc_u32 s13, s5, 0
  s_and_b32 s13, s13, 0xffff
  s_mov_b32 s14, 4096
  s_mov_b32 s15, 0x00020000
  v_lshlrev_b32 v11, 12, v0
  v_mov_b32 v12, 1
  s_and_b32 s9, s11, 31
  s_lshl_b32 s9, s9, 7
  s_lshr_b32 s10, s11, 5
  s_lshl_b32 s10, s10, 2
  s_add_u32 s9, s9, s10
  buffer_store_dword v12, v11, s[12:15], s9 offen sc1
K2_FFT_END:
  s_endpgm
K2_F2:
  s_sub_u32 s29, s2, 225
  s_getpc_b64 s[34:35]
  s_add_u32 s34, s34, tblG@rel32@lo+4
  s_addc_u32 s35, s35, tblG@rel32@hi+12
  s_and_b32 s24, s29, 7
  s_lshl_b32 s24, s24, 2
  s_lshr_b32 s9, s29, 3
  s_and_b32 s10, s9, 3
  s_add_u32 s24, s24, s10
  s_lshr_b32 s25, s9, 2
  s_waitcnt lgkmcnt(0)
  s_add_u32 s12, s4, 0
  s_addc_u32 s13, s5, 0
  s_and_b32 s13, s13, 0xffff
  s_mov_b32 s14, 7340032
  s_mov_b32 s15, 0x00020000
  s_mov_b32 s16, s6
  s_and_b32 s17, s7, 0xffff
  s_mov_b32 s18, 1605632
  s_mov_b32 s19, 0x00020000
  s_mov_b32 s20, s42
  s_and_b32 s21, s43, 0xffff
  s_mov_b32 s22, 1835008
  s_mov_b32 s23, 0x00020000
  s_add_u32 s44, s4, 15728640
  s_addc_u32 s45, s5, 0
  s_and_b32 s45, s45, 0xffff
  s_mov_b32 s46, 1835008
  s_mov_b32 s47, 0x00020000
  s_mov_b32 s48, s34
  s_and_b32 s49, s35, 0xffff
  s_mov_b32 s50, 401408
  s_mov_b32 s51, 0x00020000
  s_add_u32 s52, s4, 14680064
  s_addc_u32 s53, s5, 0
  s_and_b32 s53, s53, 0xffff
  s_mov_b32 s54, 8192
  s_mov_b32 s55, 0x00020000
  s_add_u32 s56, s4, 19922944
  s_addc_u32 s57, s5, 0
  s_and_b32 s57, s57, 0xffff
  s_mov_b32 s58, 4096
  s_mov_b32 s59, 0x00020000
  v_and_b32 v1, 63, v0
  v_lshrrev_b32 v12, 3, v1
  s_lshl_b32 s9, s8, 4
  v_add_u32 v12, s9, v12
  s_lshl_b32 s9, s24, 6
  v_add_u32 v15, s9, v12
  v_mul_u32_u24 v15, 3584, v15
  v_lshrrev_b32 v13, 4, v1
  v_and_b32 v14, 7, v1
  v_xor_b32 v14, v14, v13
  v_lshl_add_u32 v2, v14, 4, v15
  v_xor_b32 v14, 4, v14
  v_lshl_add_u32 v3, v14, 4, v15
  v_add_u32 v3, 28672, v3
  v_bfe_u32 v13, v1, 4, 1
  v_bfe_u32 v14, v1, 1, 2
  v_xor_b32 v14, v14, v13
  v_and_b32 v13, 1, v1
  v_lshlrev_b32 v13, 4, v13
  v_lshl_add_u32 v13, v14, 5, v13
  v_xor_b32 v14, 64, v13
  v_mul_u32_u24 v15, 896, v12
  s_lshl_b32 s9, s25, 7
  v_add_u32 v15, s9, v15
  v_add_u32 v4, v15, v13
  v_add_u32 v5, v15, v14
  v_add_u32 v5, 7168, v5
  v_lshlrev_b32 v15, 12, v12
  s_lshl_b32 s9, s24, 7
  v_add_u32 v15, s9, v15
  v_add_u32 v16, v15, v13
  v_add_u32 v17, v15, v14
  v_add_u32 v17, 32768, v17
  v_lshrrev_b32 v21, 1, v1
  v_lshlrev_b32 v21, 7, v21
  v_and_b32 v24, 1, v1
  v_lshl_add_u32 v21, v24, 4, v21
  s_lshl_b32 s28, s8, 11
  v_and_b32 v22, 15, v1
  s_lshl_b32 s9, s24, 6
  s_lshr_b32 s10, s8, 1
  s_lshl_b32 s10, s10, 5
  s_add_u32 s9, s9, s10
  v_add_lshl_u32 v24, v22, s9, 2
  buffer_load_dword v22, v24, s[52:55], 0 offen
  buffer_load_dword v23, v24, s[52:55], 0 offen offset:64
  s_mov_b32 s26, 0
  s_add_u32 m0, s28, 0
  s_nop 0
  buffer_load_dwordx4 v2, s[12:15], s26 offen lds
  s_mov_b32 s27, 0
  s_add_u32 m0, s28, 8192
  s_nop 0
  buffer_load_dwordx4 v4, s[16:19], s27 offen lds
  s_mov_b32 s26, 0
  s_add_u32 m0, s28, 1024
  s_nop 0
  buffer_load_dwordx4 v3, s[12:15], s26 offen lds
  s_mov_b32 s27, 0
  s_add_u32 m0, s28, 9216
  s_nop 0
  buffer_load_dwordx4 v5, s[16:19], s27 offen lds
  s_mov_b32 s26, 128
  s_add_u32 m0, s28, 16384
  s_nop 0
  buffer_load_dwordx4 v2, s[12:15], s26 offen lds
  s_mov_b32 s27, 57344
  s_add_u32 m0, s28, 24576
  s_nop 0
  buffer_load_dwordx4 v4, s[16:19], s27 offen lds
  s_mov_b32 s26, 128
  s_add_u32 m0, s28, 17408
  s_nop 0
  buffer_load_dwordx4 v3, s[12:15], s26 offen lds
  s_mov_b32 s27, 57344
  s_add_u32 m0, s28, 25600
  s_nop 0
  buffer_load_dwordx4 v5, s[16:19], s27 offen lds
  s_mov_b32 s26, 256
  s_add_u32 m0, s28, 32768
  s_nop 0
  buffer_load_dwordx4 v2, s[12:15], s26 offen lds
  s_mov_b32 s27, 114688
  s_add_u32 m0, s28, 40960
  s_nop 0
  buffer_load_dwordx4 v4, s[16:19], s27 offen lds
  s_mov_b32 s26, 256
  s_add_u32 m0, s28, 33792
  s_nop 0
  buffer_load_dwordx4 v3, s[12:15], s26 offen lds
  s_mov_b32 s27, 114688
  s_add_u32 m0, s28, 41984
  s_nop 0
  buffer_load_dwordx4 v5, s[16:19], s27 offen lds
  s_mov_b32 s26, 384
  s_add_u32 m0, s28, 49152
  s_nop 0
  buffer_load_dwordx4 v2, s[12:15], s26 offen lds
  s_mov_b32 s27, 172032
  s_add_u32 m0, s28, 57344
  s_nop 0
  buffer_load_dwordx4 v4, s[16:19], s27 offen lds
  s_mov_b32 s26, 384
  s_add_u32 m0, s28, 50176
  s_nop 0
  buffer_load_dwordx4 v3, s[12:15], s26 offen lds
  s_mov_b32 s27, 172032
  s_add_u32 m0, s28, 58368
  s_nop 0
  buffer_load_dwordx4 v5, s[16:19], s27 offen lds
  v_and_b32 v12, 15, v1
  s_lshr_b32 s9, s8, 1
  s_lshl_b32 s9, s9, 5
  v_add_u32 v13, s9, v12
  v_lshlrev_b32 v13, 7, v13
  v_lshrrev_b32 v12, 1, v12
  v_lshrrev_b32 v14, 4, v1
  v_xor_b32 v12, v12, v14
  v_lshl_add_u32 v6, v12, 4, v13
  v_xor_b32 v7, 64, v6
  v_bfe_u32 v12, v1, 2, 2
  v_lshl_add_u32 v13, v14, 3, v12
  v_lshlrev_b32 v13, 7, v13
  v_and_b32 v15, 3, v1
  v_lshl_add_u32 v13, v15, 3, v13
  v_lshrrev_b32 v12, 1, v12
  v_and_b32 v14, 1, v14
  v_lshl_or_b32 v12, v14, 1, v12
  s_and_b32 s9, s8, 1
  s_lshl_b32 s9, s9, 1
  v_xor_b32 v14, s9, v12
  v_lshl_add_u32 v8, v14, 5, v13
  v_add_u32 v8, 8192, v8
  v_xor_b32 v9, 32, v8
  s_and_b32 s9, s8, 2
  v_xor_b32 v14, s9, v12
  v_lshl_add_u32 v18, v14, 5, v13
  v_xor_b32 v19, 32, v18
  v_mov_b32 v128, 0
  v_mov_b32 v129, 0
  v_mov_b32 v130, 0
  v_mov_b32 v131, 0
  v_mov_b32 v132, 0
  v_mov_b32 v133, 0
  v_mov_b32 v134, 0
  v_mov_b32 v135, 0
  v_mov_b32 v136, 0
  v_mov_b32 v137, 0
  v_mov_b32 v138, 0
  v_mov_b32 v139, 0
  v_mov_b32 v140, 0
  v_mov_b32 v141, 0
  v_mov_b32 v142, 0
  v_mov_b32 v143, 0
  v_mov_b32 v144, 0
  v_mov_b32 v145, 0
  v_mov_b32 v146, 0
  v_mov_b32 v147, 0
  v_mov_b32 v148, 0
  v_mov_b32 v149, 0
  v_mov_b32 v150, 0
  v_mov_b32 v151, 0
  v_mov_b32 v152, 0
  v_mov_b32 v153, 0
  v_mov_b32 v154, 0
  v_mov_b32 v155, 0
  v_mov_b32 v156, 0
  v_mov_b32 v157, 0
  v_mov_b32 v158, 0
  v_mov_b32 v159, 0
  s_waitcnt vmcnt(12)
  s_barrier
  ds_read_b128 v[160:163], v6 offset:0
  ds_read_b128 v[164:167], v6 offset:2048
  ds_read_b64_tr_b16 v[176:177], v8 offset:0
  ds_read_b64_tr_b16 v[178:179], v8 offset:512
  ds_read_b64_tr_b16 v[180:181], v9 offset:0
  ds_read_b64_tr_b16 v[182:183], v9 offset:512
  ds_read_b128 v[168:171], v7 offset:0
  ds_read_b128 v[172:175], v7 offset:2048
  ds_read_b64_tr_b16 v[184:185], v8 offset:4096
  ds_read_b64_tr_b16 v[186:187], v8 offset:4608
  ds_read_b64_tr_b16 v[188:189], v9 offset:4096
  ds_read_b64_tr_b16 v[190:191], v9 offset:4608
  s_waitcnt vmcnt(8) lgkmcnt(0)
  s_barrier
  ds_read_b128 v[192:195], v6 offset:16384
  ds_read_b128 v[196:199], v6 offset:18432
  v_mfma_f32_16x16x32_bf16 v[128:131], v[176:179], v[160:163], v[128:131]
  ds_read_b64_tr_b16 v[208:209], v8 offset:16384
  ds_read_b64_tr_b16 v[210:211], v8 offset:16896
  v_mfma_f32_16x16x32_bf16 v[132:135], v[180:183], v[160:163], v[132:135]
  s_mov_b32 s26, 512
  s_add_u32 m0, s28, 0
  s_nop 0
  buffer_load_dwordx4 v2, s[12:15], s26 offen lds
  ds_read_b64_tr_b16 v[212:213], v9 offset:16384
  ds_read_b64_tr_b16 v[214:215], v9 offset:16896
  v_mfma_f32_16x16x32_bf16 v[136:139], v[176:179], v[164:167], v[136:139]
  ds_read_b128 v[200:203], v7 offset:16384
  ds_read_b128 v[204:207], v7 offset:18432
  v_mfma_f32_16x16x32_bf16 v[140:143], v[180:183], v[164:167], v[140:143]
  s_mov_b32 s27, 229376
  s_add_u32 m0, s28, 8192
  s_nop 0
  buffer_load_dwordx4 v4, s[16:19], s27 offen lds
  ds_read_b64_tr_b16 v[216:217], v8 offset:20480
  ds_read_b64_tr_b16 v[218:219], v8 offset:20992
  v_mfma_f32_16x16x32_bf16 v[128:131], v[184:187], v[168:171], v[128:131]
  ds_read_b64_tr_b16 v[220:221], v9 offset:20480
  ds_read_b64_tr_b16 v[222:223], v9 offset:20992
  v_mfma_f32_16x16x32_bf16 v[132:135], v[188:191], v[168:171], v[132:135]
  s_mov_b32 s26, 512
  s_add_u32 m0, s28, 1024
  s_nop 0
  buffer_load_dwordx4 v3, s[12:15], s26 offen lds
  v_mfma_f32_16x16x32_bf16 v[136:139], v[184:187], v[172:175], v[136:139]
  v_mfma_f32_16x16x32_bf16 v[140:143], v[188:191], v[172:175], v[140:143]
  s_mov_b32 s27, 229376
  s_add_u32 m0, s28, 9216
  s_nop 0
  buffer_load_dwordx4 v5, s[16:19], s27 offen lds
  s_waitcnt vmcnt(8) lgkmcnt(0)
  s_barrier
  ds_read_b128 v[160:163], v6 offset:32768
  ds_read_b128 v[164:167], v6 offset:34816
  v_mfma_f32_16x16x32_bf16 v[128:131], v[208:211], v[192:195], v[128:131]
  ds_read_b64_tr_b16 v[176:177], v8 offset:32768
  ds_read_b64_tr_b16 v[178:179], v8 offset:33280
  v_mfma_f32_16x16x32_bf16 v[132:135], v[212:215], v[192:195], v[132:135]
  s_mov_b32 s26, 640
  s_add_u32 m0, s28, 16384
  s_nop 0
  buffer_load_dwordx4 v2, s[12:15], s26 offen lds
  ds_read_b64_tr_b16 v[180:181], v9 offset:32768
  ds_read_b64_tr_b16 v[182:183], v9 offset:33280
  v_mfma_f32_16x16x32_bf16 v[136:139], v[208:211], v[196:199], v[136:139]
  ds_read_b128 v[168:171], v7 offset:32768
  ds_read_b128 v[172:175], v7 offset:34816
  v_mfma_f32_16x16x32_bf16 v[140:143], v[212:215], v[196:199], v[140:143]
  s_mov_b32 s27, 286720
  s_add_u32 m0, s28, 24576
  s_nop 0
  buffer_load_dwordx4 v4, s[16:19], s27 offen lds
  ds_read_b64_tr_b16 v[184:185], v8 offset:36864
  ds_read_b64_tr_b16 v[186:187], v8 offset:37376
  v_mfma_f32_16x16x32_bf16 v[128:131], v[216:219], v[200:203], v[128:131]
  ds_read_b64_tr_b16 v[188:189], v9 offset:36864
  ds_read_b64_tr_b16 v[190:191], v9 offset:37376
  v_mfma_f32_16x16x32_bf16 v[132:135], v[220:223], v[200:203], v[132:135]
  s_mov_b32 s26, 640
  s_add_u32 m0, s28, 17408
  s_nop 0
  buffer_load_dwordx4 v3, s[12:15], s26 offen lds
  v_mfma_f32_16x16x32_bf16 v[136:139], v[216:219], v[204:207], v[136:139]
  v_mfma_f32_16x16x32_bf16 v[140:143], v[220:223], v[204:207], v[140:143]
  s_mov_b32 s27, 286720
  s_add_u32 m0, s28, 25600
  s_nop 0
  buffer_load_dwordx4 v5, s[16:19], s27 offen lds
  s_waitcnt vmcnt(8) lgkmcnt(0)
  s_barrier
  ds_read_b128 v[192:195], v6 offset:49152
  ds_read_b128 v[196:199], v6 offset:51200
  v_mfma_f32_16x16x32_bf16 v[128:131], v[176:179], v[160:163], v[128:131]
  ds_read_b64_tr_b16 v[208:209], v8 offset:49152
  ds_read_b64_tr_b16 v[210:211], v8 offset:49664
  v_mfma_f32_16x16x32_bf16 v[132:135], v[180:183], v[160:163], v[132:135]
  s_mov_b32 s26, 768
  s_add_u32 m0, s28, 32768
  s_nop 0
  buffer_load_dwordx4 v2, s[12:15], s26 offen lds
  ds_read_b64_tr_b16 v[212:213], v9 offset:49152
  ds_read_b64_tr_b16 v[214:215], v9 offset:49664
  v_mfma_f32_16x16x32_bf16 v[136:139], v[176:179], v[164:167], v[136:139]
  ds_read_b128 v[200:203], v7 offset:49152
  ds_read_b128 v[204:207], v7 offset:51200
  v_mfma_f32_16x16x32_bf16 v[140:143], v[180:183], v[164:167], v[140:143]
  s_mov_b32 s27, 344064
  s_add_u32 m0, s28, 40960
  s_nop 0
  buffer_load_dwordx4 v4, s[16:19], s27 offen lds
  ds_read_b64_tr_b16 v[216:217], v8 offset:53248
  ds_read_b64_tr_b16 v[218:219], v8 offset:53760
  v_mfma_f32_16x16x32_bf16 v[128:131], v[184:187], v[168:171], v[128:131]
  ds_read_b64_tr_b16 v[220:221], v9 offset:53248
  ds_read_b64_tr_b16 v[222:223], v9 offset:53760
  v_mfma_f32_16x16x32_bf16 v[132:135], v[188:191], v[168:171], v[132:135]
  s_mov_b32 s26, 768
  s_add_u32 m0, s28, 33792
  s_nop 0
  buffer_load_dwordx4 v3, s[12:15], s26 offen lds
  v_mfma_f32_16x16x32_bf16 v[136:139], v[184:187], v[172:175], v[136:139]
  v_mfma_f32_16x16x32_bf16 v[140:143], v[188:191], v[172:175], v[140:143]
  s_mov_b32 s27, 344064
  s_add_u32 m0, s28, 41984
  s_nop 0
  buffer_load_dwordx4 v5, s[16:19], s27 offen lds
  s_waitcnt vmcnt(8) lgkmcnt(0)
  s_barrier
  ds_read_b128 v[160:163], v6 offset:0
  ds_read_b128 v[164:167], v6 offset:2048
  v_mfma_f32_16x16x32_bf16 v[128:131], v[208:211], v[192:195], v[128:131]
  ds_read_b64_tr_b16 v[176:177], v8 offset:0
  ds_read_b64_tr_b16 v[178:179], v8 offset:512
  v_mfma_f32_16x16x32_bf16 v[132:135], v[212:215], v[192:195], v[132:135]
  s_mov_b32 s26, 896
  s_add_u32 m0, s28, 49152
  s_nop 0
  buffer_load_dwordx4 v2, s[12:15], s26 offen lds
  ds_read_b64_tr_b16 v[180:181], v9 offset:0
  ds_read_b64_tr_b16 v[182:183], v9 offset:512
  v_mfma_f32_16x16x32_bf16 v[136:139], v[208:211], v[196:199], v[136:139]
  ds_read_b128 v[168:171], v7 offset:0
  ds_read_b128 v[172:175], v7 offset:2048
  v_mfma_f32_16x16x32_bf16 v[140:143], v[212:215], v[196:199], v[140:143]
  s_mov_b32 s27, 401408
  s_add_u32 m0, s28, 57344
  s_nop 0
  buffer_load_dwordx4 v4, s[16:19], s27 offen lds
  ds_read_b64_tr_b16 v[184:185], v8 offset:4096
  ds_read_b64_tr_b16 v[186:187], v8 offset:4608
  v_mfma_f32_16x16x32_bf16 v[128:131], v[216:219], v[200:203], v[128:131]
  ds_read_b64_tr_b16 v[188:189], v9 offset:4096
  ds_read_b64_tr_b16 v[190:191], v9 offset:4608
  v_mfma_f32_16x16x32_bf16 v[132:135], v[220:223], v[200:203], v[132:135]
  s_mov_b32 s26, 896
  s_add_u32 m0, s28, 50176
  s_nop 0
  buffer_load_dwordx4 v3, s[12:15], s26 offen lds
  v_mfma_f32_16x16x32_bf16 v[136:139], v[216:219], v[204:207], v[136:139]
  v_mfma_f32_16x16x32_bf16 v[140:143], v[220:223], v[204:207], v[140:143]
  s_mov_b32 s27, 401408
  s_add_u32 m0, s28, 58368
  s_nop 0
  buffer_load_dwordx4 v5, s[16:19], s27 offen lds
  s_waitcnt vmcnt(8) lgkmcnt(0)
  s_barrier
  ds_read_b128 v[192:195], v6 offset:16384
  ds_read_b128 v[196:199], v6 offset:18432
  v_mfma_f32_16x16x32_bf16 v[128:131], v[176:179], v[160:163], v[128:131]
  ds_read_b64_tr_b16 v[208:209], v8 offset:16384
  ds_read_b64_tr_b16 v[210:211], v8 offset:16896
  v_mfma_f32_16x16x32_bf16 v[132:135], v[180:183], v[160:163], v[132:135]
  s_mov_b32 s26, 1024
  s_add_u32 m0, s28, 0
  s_nop 0
  buffer_load_dwordx4 v2, s[12:15], s26 offen lds
  ds_read_b64_tr_b16 v[212:213], v9 offset:16384
  ds_read_b64_tr_b16 v[214:215], v9 offset:16896
  v_mfma_f32_16x16x32_bf16 v[136:139], v[176:179], v[164:167], v[136:139]
  ds_read_b128 v[200:203], v7 offset:16384
  ds_read_b128 v[204:207], v7 offset:18432
  v_mfma_f32_16x16x32_bf16 v[140:143], v[180:183], v[164:167], v[140:143]
  s_mov_b32 s27, 458752
  s_add_u32 m0, s28, 8192
  s_nop 0
  buffer_load_dwordx4 v4, s[16:19], s27 offen lds
  ds_read_b64_tr_b16 v[216:217], v8 offset:20480
  ds_read_b64_tr_b16 v[218:219], v8 offset:20992
  v_mfma_f32_16x16x32_bf16 v[128:131], v[184:187], v[168:171], v[128:131]
  ds_read_b64_tr_b16 v[220:221], v9 offset:20480
  ds_read_b64_tr_b16 v[222:223], v9 offset:20992
  v_mfma_f32_16x16x32_bf16 v[132:135], v[188:191], v[168:171], v[132:135]
  s_mov_b32 s26, 1024
  s_add_u32 m0, s28, 1024
  s_nop 0
  buffer_load_dwordx4 v3, s[12:15], s26 offen lds
  v_mfma_f32_16x16x32_bf16 v[136:139], v[184:187], v[172:175], v[136:139]
  v_mfma_f32_16x16x32_bf16 v[140:143], v[188:191], v[172:175], v[140:143]
  s_mov_b32 s27, 458752
  s_add_u32 m0, s28, 9216
  s_nop 0
  buffer_load_dwordx4 v5, s[16:19], s27 offen lds
  s_waitcnt vmcnt(8) lgkmcnt(0)
  s_barrier
  ds_read_b128 v[160:163], v6 offset:32768
  ds_read_b128 v[164:167], v6 offset:34816
  v_mfma_f32_16x16x32_bf16 v[128:131], v[208:211], v[192:195], v[128:131]
  ds_read_b64_tr_b16 v[176:177], v8 offset:32768
  ds_read_b64_tr_b16 v[178:179], v8 offset:33280
  v_mfma_f32_16x16x32_bf16 v[132:135], v[212:215], v[192:195], v[132:135]
  s_mov_b32 s26, 1152
  s_add_u32 m0, s28, 16384
  s_nop 0
  buffer_load_dwordx4 v2, s[12:15], s26 offen lds
  ds_read_b64_tr_b16 v[180:181], v9 offset:32768
  ds_read_b64_tr_b16 v[182:183], v9 offset:33280
  v_mfma_f32_16x16x32_bf16 v[136:139], v[208:211], v[196:199], v[136:139]
  ds_read_b128 v[168:171], v7 offset:32768
  ds_read_b128 v[172:175], v7 offset:34816
  v_mfma_f32_16x16x32_bf16 v[140:143], v[212:215], v[196:199], v[140:143]
  s_mov_b32 s27, 516096
  s_add_u32 m0, s28, 24576
  s_nop 0
  buffer_load_dwordx4 v4, s[16:19], s27 offen lds
  ds_read_b64_tr_b16 v[184:185], v8 offset:36864
  ds_read_b64_tr_b16 v[186:187], v8 offset:37376
  v_mfma_f32_16x16x32_bf16 v[128:131], v[216:219], v[200:203], v[128:131]
  ds_read_b64_tr_b16 v[188:189], v9 offset:36864
  ds_read_b64_tr_b16 v[190:191], v9 offset:37376
  v_mfma_f32_16x16x32_bf16 v[132:135], v[220:223], v[200:203], v[132:135]
  s_mov_b32 s26, 1152
  s_add_u32 m0, s28, 17408
  s_nop 0
  buffer_load_dwordx4 v3, s[12:15], s26 offen lds
  v_mfma_f32_16x16x32_bf16 v[136:139], v[216:219], v[204:207], v[136:139]
  v_mfma_f32_16x16x32_bf16 v[140:143], v[220:223], v[204:207], v[140:143]
  s_mov_b32 s27, 516096
  s_add_u32 m0, s28, 25600
  s_nop 0
  buffer_load_dwordx4 v5, s[16:19], s27 offen lds
  s_waitcnt vmcnt(8) lgkmcnt(0)
  s_barrier
  ds_read_b128 v[192:195], v6 offset:49152
  ds_read_b128 v[196:199], v6 offset:51200
  v_mfma_f32_16x16x32_bf16 v[128:131], v[176:179], v[160:163], v[128:131]
  ds_read_b64_tr_b16 v[208:209], v8 offset:49152
  ds_read_b64_tr_b16 v[210:211], v8 offset:49664
  v_mfma_f32_16x16x32_bf16 v[132:135], v[180:183], v[160:163], v[132:135]
  s_mov_b32 s26, 1280
  s_add_u32 m0, s28, 32768
  s_nop 0
  buffer_load_dwordx4 v2, s[12:15], s26 offen lds
  ds_read_b64_tr_b16 v[212:213], v9 offset:49152
  ds_read_b64_tr_b16 v[214:215], v9 offset:49664
  v_mfma_f32_16x16x32_bf16 v[136:139], v[176:179], v[164:167], v[136:139]
  ds_read_b128 v[200:203], v7 offset:49152
  ds_read_b128 v[204:207], v7 offset:51200
  v_mfma_f32_16x16x32_bf16 v[140:143], v[180:183], v[164:167], v[140:143]
  s_mov_b32 s27, 573440
  s_add_u32 m0, s28, 40960
  s_nop 0
  buffer_load_dwordx4 v4, s[16:19], s27 offen lds
  ds_read_b64_tr_b16 v[216:217], v8 offset:53248
  ds_read_b64_tr_b16 v[218:219], v8 offset:53760
  v_mfma_f32_16x16x32_bf16 v[128:131], v[184:187], v[168:171], v[128:131]
  ds_read_b64_tr_b16 v[220:221], v9 offset:53248
  ds_read_b64_tr_b16 v[222:223], v9 offset:53760
  v_mfma_f32_16x16x32_bf16 v[132:135], v[188:191], v[168:171], v[132:135]
  s_mov_b32 s26, 1280
  s_add_u32 m0, s28, 33792
  s_nop 0
  buffer_load_dwordx4 v3, s[12:15], s26 offen lds
  v_mfma_f32_16x16x32_bf16 v[136:139], v[184:187], v[172:175], v[136:139]
  v_mfma_f32_16x16x32_bf16 v[140:143], v[188:191], v[172:175], v[140:143]
  s_mov_b32 s27, 573440
  s_add_u32 m0, s28, 41984
  s_nop 0
  buffer_load_dwordx4 v5, s[16:19], s27 offen lds
  s_waitcnt vmcnt(8) lgkmcnt(0)
  s_barrier
  ds_read_b128 v[160:163], v6 offset:0
  ds_read_b128 v[164:167], v6 offset:2048
  v_mfma_f32_16x16x32_bf16 v[128:131], v[208:211], v[192:195], v[128:131]
  ds_read_b64_tr_b16 v[176:177], v8 offset:0
  ds_read_b64_tr_b16 v[178:179], v8 offset:512
  v_mfma_f32_16x16x32_bf16 v[132:135], v[212:215], v[192:195], v[132:135]
  s_mov_b32 s26, 1408
  s_add_u32 m0, s28, 49152
  s_nop 0
  buffer_load_dwordx4 v2, s[12:15], s26 offen lds
  ds_read_b64_tr_b16 v[180:181], v9 offset:0
  ds_read_b64_tr_b16 v[182:183], v9 offset:512
  v_mfma_f32_16x16x32_bf16 v[136:139], v[208:211], v[196:199], v[136:139]
  ds_read_b128 v[168:171], v7 offset:0
  ds_read_b128 v[172:175], v7 offset:2048
  v_mfma_f32_16x16x32_bf16 v[140:143], v[212:215], v[196:199], v[140:143]
  s_mov_b32 s27, 630784
  s_add_u32 m0, s28, 57344
  s_nop 0
  buffer_load_dwordx4 v4, s[16:19], s27 offen lds
  ds_read_b64_tr_b16 v[184:185], v8 offset:4096
  ds_read_b64_tr_b16 v[186:187], v8 offset:4608
  v_mfma_f32_16x16x32_bf16 v[128:131], v[216:219], v[200:203], v[128:131]
  ds_read_b64_tr_b16 v[188:189], v9 offset:4096
  ds_read_b64_tr_b16 v[190:191], v9 offset:4608
  v_mfma_f32_16x16x32_bf16 v[132:135], v[220:223], v[200:203], v[132:135]
  s_mov_b32 s26, 1408
  s_add_u32 m0, s28, 50176
  s_nop 0
  buffer_load_dwordx4 v3, s[12:15], s26 offen lds
  v_mfma_f32_16x16x32_bf16 v[136:139], v[216:219], v[204:207], v[136:139]
  v_mfma_f32_16x16x32_bf16 v[140:143], v[220:223], v[204:207], v[140:143]
  s_mov_b32 s27, 630784
  s_add_u32 m0, s28, 58368
  s_nop 0
  buffer_load_dwordx4 v5, s[16:19], s27 offen lds
  s_waitcnt vmcnt(8) lgkmcnt(0)
  s_barrier
  ds_read_b128 v[192:195], v6 offset:16384
  ds_read_b128 v[196:199], v6 offset:18432
  v_mfma_f32_16x16x32_bf16 v[128:131], v[176:179], v[160:163], v[128:131]
  ds_read_b64_tr_b16 v[208:209], v8 offset:16384
  ds_read_b64_tr_b16 v[210:211], v8 offset:16896
  v_mfma_f32_16x16x32_bf16 v[132:135], v[180:183], v[160:163], v[132:135]
  s_mov_b32 s26, 1536
  s_add_u32 m0, s28, 0
  s_nop 0
  buffer_load_dwordx4 v2, s[12:15], s26 offen lds
  ds_read_b64_tr_b16 v[212:213], v9 offset:16384
  ds_read_b64_tr_b16 v[214:215], v9 offset:16896
  v_mfma_f32_16x16x32_bf16 v[136:139], v[176:179], v[164:167], v[136:139]
  ds_read_b128 v[200:203], v7 offset:16384
  ds_read_b128 v[204:207], v7 offset:18432
  v_mfma_f32_16x16x32_bf16 v[140:143], v[180:183], v[164:167], v[140:143]
  s_mov_b32 s27, 688128
  s_add_u32 m0, s28, 8192
  s_nop 0
  buffer_load_dwordx4 v4, s[16:19], s27 offen lds
  ds_read_b64_tr_b16 v[216:217], v8 offset:20480
  ds_read_b64_tr_b16 v[218:219], v8 offset:20992
  v_mfma_f32_16x16x32_bf16 v[128:131], v[184:187], v[168:171], v[128:131]
  ds_read_b64_tr_b16 v[220:221], v9 offset:20480
  ds_read_b64_tr_b16 v[222:223], v9 offset:20992
  v_mfma_f32_16x16x32_bf16 v[132:135], v[188:191], v[168:171], v[132:135]
  s_mov_b32 s26, 1536
  s_add_u32 m0, s28, 1024
  s_nop 0
  buffer_load_dwordx4 v3, s[12:15], s26 offen lds
  v_mfma_f32_16x16x32_bf16 v[136:139], v[184:187], v[172:175], v[136:139]
  v_mfma_f32_16x16x32_bf16 v[140:143], v[188:191], v[172:175], v[140:143]
  s_mov_b32 s27, 688128
  s_add_u32 m0, s28, 9216
  s_nop 0
  buffer_load_dwordx4 v5, s[16:19], s27 offen lds
  s_waitcnt vmcnt(8) lgkmcnt(0)
  s_barrier
  ds_read_b128 v[160:163], v6 offset:32768
  ds_read_b128 v[164:167], v6 offset:34816
  v_mfma_f32_16x16x32_bf16 v[128:131], v[208:211], v[192:195], v[128:131]
  ds_read_b64_tr_b16 v[176:177], v8 offset:32768
  ds_read_b64_tr_b16 v[178:179], v8 offset:33280
  v_mfma_f32_16x16x32_bf16 v[132:135], v[212:215], v[192:195], v[132:135]
  s_mov_b32 s26, 1664
  s_add_u32 m0, s28, 16384
  s_nop 0
  buffer_load_dwordx4 v2, s[12:15], s26 offen lds
  ds_read_b64_tr_b16 v[180:181], v9 offset:32768
  ds_read_b64_tr_b16 v[182:183], v9 offset:33280
  v_mfma_f32_16x16x32_bf16 v[136:139], v[208:211], v[196:199], v[136:139]
  ds_read_b128 v[168:171], v7 offset:32768
  ds_read_b128 v[172:175], v7 offset:34816
  v_mfma_f32_16x16x32_bf16 v[140:143], v[212:215], v[196:199], v[140:143]
  s_mov_b32 s27, 745472
  s_add_u32 m0, s28, 24576
  s_nop 0
  buffer_load_dwordx4 v4, s[16:19], s27 offen lds
  ds_read_b64_tr_b16 v[184:185], v8 offset:36864
  ds_read_b64_tr_b16 v[186:187], v8 offset:37376
  v_mfma_f32_16x16x32_bf16 v[128:131], v[216:219], v[200:203], v[128:131]
  ds_read_b64_tr_b16 v[188:189], v9 offset:36864
  ds_read_b64_tr_b16 v[190:191], v9 offset:37376
  v_mfma_f32_16x16x32_bf16 v[132:135], v[220:223], v[200:203], v[132:135]
  s_mov_b32 s26, 1664
  s_add_u32 m0, s28, 17408
  s_nop 0
  buffer_load_dwordx4 v3, s[12:15], s26 offen lds
  v_mfma_f32_16x16x32_bf16 v[136:139], v[216:219], v[204:207], v[136:139]
  v_mfma_f32_16x16x32_bf16 v[140:143], v[220:223], v[204:207], v[140:143]
  s_mov_b32 s27, 745472
  s_add_u32 m0, s28, 25600
  s_nop 0
  buffer_load_dwordx4 v5, s[16:19], s27 offen lds
  s_waitcnt vmcnt(8) lgkmcnt(0)
  s_barrier
  ds_read_b128 v[192:195], v6 offset:49152
  ds_read_b128 v[196:199], v6 offset:51200
  v_mfma_f32_16x16x32_bf16 v[128:131], v[176:179], v[160:163], v[128:131]
  ds_read_b64_tr_b16 v[208:209], v8 offset:49152
  ds_read_b64_tr_b16 v[210:211], v8 offset:49664
  v_mfma_f32_16x16x32_bf16 v[132:135], v[180:183], v[160:163], v[132:135]
  s_mov_b32 s26, 1792
  s_add_u32 m0, s28, 32768
  s_nop 0
  buffer_load_dwordx4 v2, s[12:15], s26 offen lds
  ds_read_b64_tr_b16 v[212:213], v9 offset:49152
  ds_read_b64_tr_b16 v[214:215], v9 offset:49664
  v_mfma_f32_16x16x32_bf16 v[136:139], v[176:179], v[164:167], v[136:139]
  ds_read_b128 v[200:203], v7 offset:49152
  ds_read_b128 v[204:207], v7 offset:51200
  v_mfma_f32_16x16x32_bf16 v[140:143], v[180:183], v[164:167], v[140:143]
  s_mov_b32 s27, 802816
  s_add_u32 m0, s28, 40960
  s_nop 0
  buffer_load_dwordx4 v4, s[16:19], s27 offen lds
  ds_read_b64_tr_b16 v[216:217], v8 offset:53248
  ds_read_b64_tr_b16 v[218:219], v8 offset:53760
  v_mfma_f32_16x16x32_bf16 v[128:131], v[184:187], v[168:171], v[128:131]
  ds_read_b64_tr_b16 v[220:221], v9 offset:53248
  ds_read_b64_tr_b16 v[222:223], v9 offset:53760
  v_mfma_f32_16x16x32_bf16 v[132:135], v[188:191], v[168:171], v[132:135]
  s_mov_b32 s26, 1792
  s_add_u32 m0, s28, 33792
  s_nop 0
  buffer_load_dwordx4 v3, s[12:15], s26 offen lds
  v_mfma_f32_16x16x32_bf16 v[136:139], v[184:187], v[172:175], v[136:139]
  v_mfma_f32_16x16x32_bf16 v[140:143], v[188:191], v[172:175], v[140:143]
  s_mov_b32 s27, 802816
  s_add_u32 m0, s28, 41984
  s_nop 0
  buffer_load_dwordx4 v5, s[16:19], s27 offen lds
  s_waitcnt vmcnt(8) lgkmcnt(0)
  s_barrier
  ds_read_b128 v[160:163], v6 offset:0
  ds_read_b128 v[164:167], v6 offset:2048
  v_mfma_f32_16x16x32_bf16 v[128:131], v[208:211], v[192:195], v[128:131]
  ds_read_b64_tr_b16 v[176:177], v8 offset:0
  ds_read_b64_tr_b16 v[178:179], v8 offset:512
  v_mfma_f32_16x16x32_bf16 v[132:135], v[212:215], v[192:195], v[132:135]
  s_mov_b32 s26, 1920
  s_add_u32 m0, s28, 49152
  s_nop 0
  buffer_load_dwordx4 v2, s[12:15], s26 offen lds
  ds_read_b64_tr_b16 v[180:181], v9 offset:0
  ds_read_b64_tr_b16 v[182:183], v9 offset:512
  v_mfma_f32_16x16x32_bf16 v[136:139], v[208:211], v[196:199], v[136:139]
  ds_read_b128 v[168:171], v7 offset:0
  ds_read_b128 v[172:175], v7 offset:2048
  v_mfma_f32_16x16x32_bf16 v[140:143], v[212:215], v[196:199], v[140:143]
  s_mov_b32 s27, 860160
  s_add_u32 m0, s28, 57344
  s_nop 0
  buffer_load_dwordx4 v4, s[16:19], s27 offen lds
  ds_read_b64_tr_b16 v[184:185], v8 offset:4096
  ds_read_b64_tr_b16 v[186:187], v8 offset:4608
  v_mfma_f32_16x16x32_bf16 v[128:131], v[216:219], v[200:203], v[128:131]
  ds_read_b64_tr_b16 v[188:189], v9 offset:4096
  ds_read_b64_tr_b16 v[190:191], v9 offset:4608
  v_mfma_f32_16x16x32_bf16 v[132:135], v[220:223], v[200:203], v[132:135]
  s_mov_b32 s26, 1920
  s_add_u32 m0, s28, 50176
  s_nop 0
  buffer_load_dwordx4 v3, s[12:15], s26 offen lds
  v_mfma_f32_16x16x32_bf16 v[136:139], v[216:219], v[204:207], v[136:139]
  v_mfma_f32_16x16x32_bf16 v[140:143], v[220:223], v[204:207], v[140:143]
  s_mov_b32 s27, 860160
  s_add_u32 m0, s28, 58368
  s_nop 0
  buffer_load_dwordx4 v5, s[16:19], s27 offen lds
  s_waitcnt vmcnt(8) lgkmcnt(0)
  s_barrier
  ds_read_b128 v[192:195], v6 offset:16384
  ds_read_b128 v[196:199], v6 offset:18432
  v_mfma_f32_16x16x32_bf16 v[128:131], v[176:179], v[160:163], v[128:131]
  ds_read_b64_tr_b16 v[208:209], v8 offset:16384
  ds_read_b64_tr_b16 v[210:211], v8 offset:16896
  v_mfma_f32_16x16x32_bf16 v[132:135], v[180:183], v[160:163], v[132:135]
  s_mov_b32 s26, 2048
  s_add_u32 m0, s28, 0
  s_nop 0
  buffer_load_dwordx4 v2, s[12:15], s26 offen lds
  ds_read_b64_tr_b16 v[212:213], v9 offset:16384
  ds_read_b64_tr_b16 v[214:215], v9 offset:16896
  v_mfma_f32_16x16x32_bf16 v[136:139], v[176:179], v[164:167], v[136:139]
  ds_read_b128 v[200:203], v7 offset:16384
  ds_read_b128 v[204:207], v7 offset:18432
  v_mfma_f32_16x16x32_bf16 v[140:143], v[180:183], v[164:167], v[140:143]
  s_mov_b32 s27, 917504
  s_add_u32 m0, s28, 8192
  s_nop 0
  buffer_load_dwordx4 v4, s[16:19], s27 offen lds
  ds_read_b64_tr_b16 v[216:217], v8 offset:20480
  ds_read_b64_tr_b16 v[218:219], v8 offset:20992
  v_mfma_f32_16x16x32_bf16 v[128:131], v[184:187], v[168:171], v[128:131]
  ds_read_b64_tr_b16 v[220:221], v9 offset:20480
  ds_read_b64_tr_b16 v[222:223], v9 offset:20992
  v_mfma_f32_16x16x32_bf16 v[132:135], v[188:191], v[168:171], v[132:135]
  s_mov_b32 s26, 2048
  s_add_u32 m0, s28, 1024
  s_nop 0
  buffer_load_dwordx4 v3, s[12:15], s26 offen lds
  v_mfma_f32_16x16x32_bf16 v[136:139], v[184:187], v[172:175], v[136:139]
  v_mfma_f32_16x16x32_bf16 v[140:143], v[188:191], v[172:175], v[140:143]
  s_mov_b32 s27, 917504
  s_add_u32 m0, s28, 9216
  s_nop 0
  buffer_load_dwordx4 v5, s[16:19], s27 offen lds
  s_waitcnt vmcnt(8) lgkmcnt(0)
  s_barrier
  ds_read_b128 v[160:163], v6 offset:32768
  ds_read_b128 v[164:167], v6 offset:34816
  v_mfma_f32_16x16x32_bf16 v[128:131], v[208:211], v[192:195], v[128:131]
  ds_read_b64_tr_b16 v[176:177], v8 offset:32768
  ds_read_b64_tr_b16 v[178:179], v8 offset:33280
  v_mfma_f32_16x16x32_bf16 v[132:135], v[212:215], v[192:195], v[132:135]
  s_mov_b32 s26, 2176
  s_add_u32 m0, s28, 16384
  s_nop 0
  buffer_load_dwordx4 v2, s[12:15], s26 offen lds
  ds_read_b64_tr_b16 v[180:181], v9 offset:32768
  ds_read_b64_tr_b16 v[182:183], v9 offset:33280
  v_mfma_f32_16x16x32_bf16 v[136:139], v[208:211], v[196:199], v[136:139]
  ds_read_b128 v[168:171], v7 offset:32768
  ds_read_b128 v[172:175], v7 offset:34816
  v_mfma_f32_16x16x32_bf16 v[140:143], v[212:215], v[196:199], v[140:143]
  s_mov_b32 s27, 974848
  s_add_u32 m0, s28, 24576
  s_nop 0
  buffer_load_dwordx4 v4, s[16:19], s27 offen lds
  ds_read_b64_tr_b16 v[184:185], v8 offset:36864
  ds_read_b64_tr_b16 v[186:187], v8 offset:37376
  v_mfma_f32_16x16x32_bf16 v[128:131], v[216:219], v[200:203], v[128:131]
  ds_read_b64_tr_b16 v[188:189], v9 offset:36864
  ds_read_b64_tr_b16 v[190:191], v9 offset:37376
  v_mfma_f32_16x16x32_bf16 v[132:135], v[220:223], v[200:203], v[132:135]
  s_mov_b32 s26, 2176
  s_add_u32 m0, s28, 17408
  s_nop 0
  buffer_load_dwordx4 v3, s[12:15], s26 offen lds
  v_mfma_f32_16x16x32_bf16 v[136:139], v[216:219], v[204:207], v[136:139]
  v_mfma_f32_16x16x32_bf16 v[140:143], v[220:223], v[204:207], v[140:143]
  s_mov_b32 s27, 974848
  s_add_u32 m0, s28, 25600
  s_nop 0
  buffer_load_dwordx4 v5, s[16:19], s27 offen lds
  s_waitcnt vmcnt(8) lgkmcnt(0)
  s_barrier
  ds_read_b128 v[192:195], v6 offset:49152
  ds_read_b128 v[196:199], v6 offset:51200
  v_mfma_f32_16x16x32_bf16 v[128:131], v[176:179], v[160:163], v[128:131]
  ds_read_b64_tr_b16 v[208:209], v8 offset:49152
  ds_read_b64_tr_b16 v[210:211], v8 offset:49664
  v_mfma_f32_16x16x32_bf16 v[132:135], v[180:183], v[160:163], v[132:135]
  s_mov_b32 s26, 2304
  s_add_u32 m0, s28, 32768
  s_nop 0
  buffer_load_dwordx4 v2, s[12:15], s26 offen lds
  ds_read_b64_tr_b16 v[212:213], v9 offset:49152
  ds_read_b64_tr_b16 v[214:215], v9 offset:49664
  v_mfma_f32_16x16x32_bf16 v[136:139], v[176:179], v[164:167], v[136:139]
  ds_read_b128 v[200:203], v7 offset:49152
  ds_read_b128 v[204:207], v7 offset:51200
  v_mfma_f32_16x16x32_bf16 v[140:143], v[180:183], v[164:167], v[140:143]
  s_mov_b32 s27, 1032192
  s_add_u32 m0, s28, 40960
  s_nop 0
  buffer_load_dwordx4 v4, s[16:19], s27 offen lds
  ds_read_b64_tr_b16 v[216:217], v8 offset:53248
  ds_read_b64_tr_b16 v[218:219], v8 offset:53760
  v_mfma_f32_16x16x32_bf16 v[128:131], v[184:187], v[168:171], v[128:131]
  ds_read_b64_tr_b16 v[220:221], v9 offset:53248
  ds_read_b64_tr_b16 v[222:223], v9 offset:53760
  v_mfma_f32_16x16x32_bf16 v[132:135], v[188:191], v[168:171], v[132:135]
  s_mov_b32 s26, 2304
  s_add_u32 m0, s28, 33792
  s_nop 0
  buffer_load_dwordx4 v3, s[12:15], s26 offen lds
  v_mfma_f32_16x16x32_bf16 v[136:139], v[184:187], v[172:175], v[136:139]
  v_mfma_f32_16x16x32_bf16 v[140:143], v[188:191], v[172:175], v[140:143]
  s_mov_b32 s27, 1032192
  s_add_u32 m0, s28, 41984
  s_nop 0
  buffer_load_dwordx4 v5, s[16:19], s27 offen lds
  s_waitcnt vmcnt(8) lgkmcnt(0)
  s_barrier
  ds_read_b128 v[160:163], v6 offset:0
  ds_read_b128 v[164:167], v6 offset:2048
  v_mfma_f32_16x16x32_bf16 v[128:131], v[208:211], v[192:195], v[128:131]
  ds_read_b64_tr_b16 v[176:177], v8 offset:0
  ds_read_b64_tr_b16 v[178:179], v8 offset:512
  v_mfma_f32_16x16x32_bf16 v[132:135], v[212:215], v[192:195], v[132:135]
  s_mov_b32 s26, 2432
  s_add_u32 m0, s28, 49152
  s_nop 0
  buffer_load_dwordx4 v2, s[12:15], s26 offen lds
  ds_read_b64_tr_b16 v[180:181], v9 offset:0
  ds_read_b64_tr_b16 v[182:183], v9 offset:512
  v_mfma_f32_16x16x32_bf16 v[136:139], v[208:211], v[196:199], v[136:139]
  ds_read_b128 v[168:171], v7 offset:0
  ds_read_b128 v[172:175], v7 offset:2048
  v_mfma_f32_16x16x32_bf16 v[140:143], v[212:215], v[196:199], v[140:143]
  s_mov_b32 s27, 1089536
  s_add_u32 m0, s28, 57344
  s_nop 0
  buffer_load_dwordx4 v4, s[16:19], s27 offen lds
  ds_read_b64_tr_b16 v[184:185], v8 offset:4096
  ds_read_b64_tr_b16 v[186:187], v8 offset:4608
  v_mfma_f32_16x16x32_bf16 v[128:131], v[216:219], v[200:203], v[128:131]
  ds_read_b64_tr_b16 v[188:189], v9 offset:4096
  ds_read_b64_tr_b16 v[190:191], v9 offset:4608
  v_mfma_f32_16x16x32_bf16 v[132:135], v[220:223], v[200:203], v[132:135]
  s_mov_b32 s26, 2432
  s_add_u32 m0, s28, 50176
  s_nop 0
  buffer_load_dwordx4 v3, s[12:15], s26 offen lds
  v_mfma_f32_16x16x32_bf16 v[136:139], v[216:219], v[204:207], v[136:139]
  v_mfma_f32_16x16x32_bf16 v[140:143], v[220:223], v[204:207], v[140:143]
  s_mov_b32 s27, 1089536
  s_add_u32 m0, s28, 58368
  s_nop 0
  buffer_load_dwordx4 v5, s[16:19], s27 offen lds
  s_waitcnt vmcnt(8) lgkmcnt(0)
  s_barrier
  ds_read_b128 v[192:195], v6 offset:16384
  ds_read_b128 v[196:199], v6 offset:18432
  v_mfma_f32_16x16x32_bf16 v[128:131], v[176:179], v[160:163], v[128:131]
  ds_read_b64_tr_b16 v[208:209], v8 offset:16384
  ds_read_b64_tr_b16 v[210:211], v8 offset:16896
  v_mfma_f32_16x16x32_bf16 v[132:135], v[180:183], v[160:163], v[132:135]
  s_mov_b32 s26, 2560
  s_add_u32 m0, s28, 0
  s_nop 0
  buffer_load_dwordx4 v2, s[12:15], s26 offen lds
  ds_read_b64_tr_b16 v[212:213], v9 offset:16384
  ds_read_b64_tr_b16 v[214:215], v9 offset:16896
  v_mfma_f32_16x16x32_bf16 v[136:139], v[176:179], v[164:167], v[136:139]
  ds_read_b128 v[200:203], v7 offset:16384
  ds_read_b128 v[204:207], v7 offset:18432
  v_mfma_f32_16x16x32_bf16 v[140:143], v[180:183], v[164:167], v[140:143]
  s_mov_b32 s27, 1146880
  s_add_u32 m0, s28, 8192
  s_nop 0
  buffer_load_dwordx4 v4, s[16:19], s27 offen lds
  ds_read_b64_tr_b16 v[216:217], v8 offset:20480
  ds_read_b64_tr_b16 v[218:219], v8 offset:20992
  v_mfma_f32_16x16x32_bf16 v[128:131], v[184:187], v[168:171], v[128:131]
  ds_read_b64_tr_b16 v[220:221], v9 offset:20480
  ds_read_b64_tr_b16 v[222:223], v9 offset:20992
  v_mfma_f32_16x16x32_bf16 v[132:135], v[188:191], v[168:171], v[132:135]
  s_mov_b32 s26, 2560
  s_add_u32 m0, s28, 1024
  s_nop 0
  buffer_load_dwordx4 v3, s[12:15], s26 offen lds
  v_mfma_f32_16x16x32_bf16 v[136:139], v[184:187], v[172:175], v[136:139]
  v_mfma_f32_16x16x32_bf16 v[140:143], v[188:191], v[172:175], v[140:143]
  s_mov_b32 s27, 1146880
  s_add_u32 m0, s28, 9216
  s_nop 0
  buffer_load_dwordx4 v5, s[16:19], s27 offen lds
  s_waitcnt vmcnt(8) lgkmcnt(0)
  s_barrier
  ds_read_b128 v[160:163], v6 offset:32768
  ds_read_b128 v[164:167], v6 offset:34816
  v_mfma_f32_16x16x32_bf16 v[128:131], v[208:211], v[192:195], v[128:131]
  ds_read_b64_tr_b16 v[176:177], v8 offset:32768
  ds_read_b64_tr_b16 v[178:179], v8 offset:33280
  v_mfma_f32_16x16x32_bf16 v[132:135], v[212:215], v[192:195], v[132:135]
  s_mov_b32 s26, 2688
  s_add_u32 m0, s28, 16384
  s_nop 0
  buffer_load_dwordx4 v2, s[12:15], s26 offen lds
  ds_read_b64_tr_b16 v[180:181], v9 offset:32768
  ds_read_b64_tr_b16 v[182:183], v9 offset:33280
  v_mfma_f32_16x16x32_bf16 v[136:139], v[208:211], v[196:199], v[136:139]
  ds_read_b128 v[168:171], v7 offset:32768
  ds_read_b128 v[172:175], v7 offset:34816
  v_mfma_f32_16x16x32_bf16 v[140:143], v[212:215], v[196:199], v[140:143]
  s_mov_b32 s27, 1204224
  s_add_u32 m0, s28, 24576
  s_nop 0
  buffer_load_dwordx4 v4, s[16:19], s27 offen lds
  ds_read_b64_tr_b16 v[184:185], v8 offset:36864
  ds_read_b64_tr_b16 v[186:187], v8 offset:37376
  v_mfma_f32_16x16x32_bf16 v[128:131], v[216:219], v[200:203], v[128:131]
  ds_read_b64_tr_b16 v[188:189], v9 offset:36864
  ds_read_b64_tr_b16 v[190:191], v9 offset:37376
  v_mfma_f32_16x16x32_bf16 v[132:135], v[220:223], v[200:203], v[132:135]
  s_mov_b32 s26, 2688
  s_add_u32 m0, s28, 17408
  s_nop 0
  buffer_load_dwordx4 v3, s[12:15], s26 offen lds
  v_mfma_f32_16x16x32_bf16 v[136:139], v[216:219], v[204:207], v[136:139]
  v_mfma_f32_16x16x32_bf16 v[140:143], v[220:223], v[204:207], v[140:143]
  s_mov_b32 s27, 1204224
  s_add_u32 m0, s28, 25600
  s_nop 0
  buffer_load_dwordx4 v5, s[16:19], s27 offen lds
  s_waitcnt vmcnt(8) lgkmcnt(0)
  s_barrier
  ds_read_b128 v[192:195], v6 offset:49152
  ds_read_b128 v[196:199], v6 offset:51200
  v_mfma_f32_16x16x32_bf16 v[128:131], v[176:179], v[160:163], v[128:131]
  ds_read_b64_tr_b16 v[208:209], v8 offset:49152
  ds_read_b64_tr_b16 v[210:211], v8 offset:49664
  v_mfma_f32_16x16x32_bf16 v[132:135], v[180:183], v[160:163], v[132:135]
  s_mov_b32 s26, 2816
  s_add_u32 m0, s28, 32768
  s_nop 0
  buffer_load_dwordx4 v2, s[12:15], s26 offen lds
  ds_read_b64_tr_b16 v[212:213], v9 offset:49152
  ds_read_b64_tr_b16 v[214:215], v9 offset:49664
  v_mfma_f32_16x16x32_bf16 v[136:139], v[176:179], v[164:167], v[136:139]
  ds_read_b128 v[200:203], v7 offset:49152
  ds_read_b128 v[204:207], v7 offset:51200
  v_mfma_f32_16x16x32_bf16 v[140:143], v[180:183], v[164:167], v[140:143]
  s_mov_b32 s27, 1261568
  s_add_u32 m0, s28, 40960
  s_nop 0
  buffer_load_dwordx4 v4, s[16:19], s27 offen lds
  ds_read_b64_tr_b16 v[216:217], v8 offset:53248
  ds_read_b64_tr_b16 v[218:219], v8 offset:53760
  v_mfma_f32_16x16x32_bf16 v[128:131], v[184:187], v[168:171], v[128:131]
  ds_read_b64_tr_b16 v[220:221], v9 offset:53248
  ds_read_b64_tr_b16 v[222:223], v9 offset:53760
  v_mfma_f32_16x16x32_bf16 v[132:135], v[188:191], v[168:171], v[132:135]
  s_mov_b32 s26, 2816
  s_add_u32 m0, s28, 33792
  s_nop 0
  buffer_load_dwordx4 v3, s[12:15], s26 offen lds
  v_mfma_f32_16x16x32_bf16 v[136:139], v[184:187], v[172:175], v[136:139]
  v_mfma_f32_16x16x32_bf16 v[140:143], v[188:191], v[172:175], v[140:143]
  s_mov_b32 s27, 1261568
  s_add_u32 m0, s28, 41984
  s_nop 0
  buffer_load_dwordx4 v5, s[16:19], s27 offen lds
  s_waitcnt vmcnt(8) lgkmcnt(0)
  s_barrier
  ds_read_b128 v[160:163], v6 offset:0
  ds_read_b128 v[164:167], v6 offset:2048
  v_mfma_f32_16x16x32_bf16 v[128:131], v[208:211], v[192:195], v[128:131]
  ds_read_b64_tr_b16 v[176:177], v8 offset:0
  ds_read_b64_tr_b16 v[178:179], v8 offset:512
  v_mfma_f32_16x16x32_bf16 v[132:135], v[212:215], v[192:195], v[132:135]
  s_mov_b32 s26, 2944
  s_add_u32 m0, s28, 49152
  s_nop 0
  buffer_load_dwordx4 v2, s[12:15], s26 offen lds
  ds_read_b64_tr_b16 v[180:181], v9 offset:0
  ds_read_b64_tr_b16 v[182:183], v9 offset:512
  v_mfma_f32_16x16x32_bf16 v[136:139], v[208:211], v[196:199], v[136:139]
  ds_read_b128 v[168:171], v7 offset:0
  ds_read_b128 v[172:175], v7 offset:2048
  v_mfma_f32_16x16x32_bf16 v[140:143], v[212:215], v[196:199], v[140:143]
  s_mov_b32 s27, 1318912
  s_add_u32 m0, s28, 57344
  s_nop 0
  buffer_load_dwordx4 v4, s[16:19], s27 offen lds
  ds_read_b64_tr_b16 v[184:185], v8 offset:4096
  ds_read_b64_tr_b16 v[186:187], v8 offset:4608
  v_mfma_f32_16x16x32_bf16 v[128:131], v[216:219], v[200:203], v[128:131]
  ds_read_b64_tr_b16 v[188:189], v9 offset:4096
  ds_read_b64_tr_b16 v[190:191], v9 offset:4608
  v_mfma_f32_16x16x32_bf16 v[132:135], v[220:223], v[200:203], v[132:135]
  s_mov_b32 s26, 2944
  s_add_u32 m0, s28, 50176
  s_nop 0
  buffer_load_dwordx4 v3, s[12:15], s26 offen lds
  v_mfma_f32_16x16x32_bf16 v[136:139], v[216:219], v[204:207], v[136:139]
  v_mfma_f32_16x16x32_bf16 v[140:143], v[220:223], v[204:207], v[140:143]
  s_mov_b32 s27, 1318912
  s_add_u32 m0, s28, 58368
  s_nop 0
  buffer_load_dwordx4 v5, s[16:19], s27 offen lds
  s_waitcnt vmcnt(8) lgkmcnt(0)
  s_barrier
  ds_read_b128 v[192:195], v6 offset:16384
  ds_read_b128 v[196:199], v6 offset:18432
  v_mfma_f32_16x16x32_bf16 v[128:131], v[176:179], v[160:163], v[128:131]
  ds_read_b64_tr_b16 v[208:209], v8 offset:16384
  ds_read_b64_tr_b16 v[210:211], v8 offset:16896
  v_mfma_f32_16x16x32_bf16 v[132:135], v[180:183], v[160:163], v[132:135]
  s_mov_b32 s26, 3072
  s_add_u32 m0, s28, 0
  s_nop 0
  buffer_load_dwordx4 v2, s[12:15], s26 offen lds
  ds_read_b64_tr_b16 v[212:213], v9 offset:16384
  ds_read_b64_tr_b16 v[214:215], v9 offset:16896
  v_mfma_f32_16x16x32_bf16 v[136:139], v[176:179], v[164:167], v[136:139]
  ds_read_b128 v[200:203], v7 offset:16384
  ds_read_b128 v[204:207], v7 offset:18432
  v_mfma_f32_16x16x32_bf16 v[140:143], v[180:183], v[164:167], v[140:143]
  s_mov_b32 s27, 1376256
  s_add_u32 m0, s28, 8192
  s_nop 0
  buffer_load_dwordx4 v4, s[16:19], s27 offen lds
  ds_read_b64_tr_b16 v[216:217], v8 offset:20480
  ds_read_b64_tr_b16 v[218:219], v8 offset:20992
  v_mfma_f32_16x16x32_bf16 v[128:131], v[184:187], v[168:171], v[128:131]
  ds_read_b64_tr_b16 v[220:221], v9 offset:20480
  ds_read_b64_tr_b16 v[222:223], v9 offset:20992
  v_mfma_f32_16x16x32_bf16 v[132:135], v[188:191], v[168:171], v[132:135]
  s_mov_b32 s26, 3072
  s_add_u32 m0, s28, 1024
  s_nop 0
  buffer_load_dwordx4 v3, s[12:15], s26 offen lds
  v_mfma_f32_16x16x32_bf16 v[136:139], v[184:187], v[172:175], v[136:139]
  v_mfma_f32_16x16x32_bf16 v[140:143], v[188:191], v[172:175], v[140:143]
  s_mov_b32 s27, 1376256
  s_add_u32 m0, s28, 9216
  s_nop 0
  buffer_load_dwordx4 v5, s[16:19], s27 offen lds
  s_waitcnt vmcnt(8) lgkmcnt(0)
  s_barrier
  ds_read_b128 v[160:163], v6 offset:32768
  ds_read_b128 v[164:167], v6 offset:34816
  v_mfma_f32_16x16x32_bf16 v[128:131], v[208:211], v[192:195], v[128:131]
  ds_read_b64_tr_b16 v[176:177], v8 offset:32768
  ds_read_b64_tr_b16 v[178:179], v8 offset:33280
  v_mfma_f32_16x16x32_bf16 v[132:135], v[212:215], v[192:195], v[132:135]
  s_mov_b32 s26, 3200
  s_add_u32 m0, s28, 16384
  s_nop 0
  buffer_load_dwordx4 v2, s[12:15], s26 offen lds
  ds_read_b64_tr_b16 v[180:181], v9 offset:32768
  ds_read_b64_tr_b16 v[182:183], v9 offset:33280
  v_mfma_f32_16x16x32_bf16 v[136:139], v[208:211], v[196:199], v[136:139]
  ds_read_b128 v[168:171], v7 offset:32768
  ds_read_b128 v[172:175], v7 offset:34816
  v_mfma_f32_16x16x32_bf16 v[140:143], v[212:215], v[196:199], v[140:143]
  s_mov_b32 s27, 1433600
  s_add_u32 m0, s28, 24576
  s_nop 0
  buffer_load_dwordx4 v4, s[16:19], s27 offen lds
  ds_read_b64_tr_b16 v[184:185], v8 offset:36864
  ds_read_b64_tr_b16 v[186:187], v8 offset:37376
  v_mfma_f32_16x16x32_bf16 v[128:131], v[216:219], v[200:203], v[128:131]
  ds_read_b64_tr_b16 v[188:189], v9 offset:36864
  ds_read_b64_tr_b16 v[190:191], v9 offset:37376
  v_mfma_f32_16x16x32_bf16 v[132:135], v[220:223], v[200:203], v[132:135]
  s_mov_b32 s26, 3200
  s_add_u32 m0, s28, 17408
  s_nop 0
  buffer_load_dwordx4 v3, s[12:15], s26 offen lds
  v_mfma_f32_16x16x32_bf16 v[136:139], v[216:219], v[204:207], v[136:139]
  v_mfma_f32_16x16x32_bf16 v[140:143], v[220:223], v[204:207], v[140:143]
  s_mov_b32 s27, 1433600
  s_add_u32 m0, s28, 25600
  s_nop 0
  buffer_load_dwordx4 v5, s[16:19], s27 offen lds
  s_waitcnt vmcnt(8) lgkmcnt(0)
  s_barrier
  ds_read_b128 v[192:195], v6 offset:49152
  ds_read_b128 v[196:199], v6 offset:51200
  v_mfma_f32_16x16x32_bf16 v[128:131], v[176:179], v[160:163], v[128:131]
  ds_read_b64_tr_b16 v[208:209], v8 offset:49152
  ds_read_b64_tr_b16 v[210:211], v8 offset:49664
  v_mfma_f32_16x16x32_bf16 v[132:135], v[180:183], v[160:163], v[132:135]
  s_mov_b32 s26, 3328
  s_add_u32 m0, s28, 32768
  s_nop 0
  buffer_load_dwordx4 v2, s[12:15], s26 offen lds
  ds_read_b64_tr_b16 v[212:213], v9 offset:49152
  ds_read_b64_tr_b16 v[214:215], v9 offset:49664
  v_mfma_f32_16x16x32_bf16 v[136:139], v[176:179], v[164:167], v[136:139]
  ds_read_b128 v[200:203], v7 offset:49152
  ds_read_b128 v[204:207], v7 offset:51200
  v_mfma_f32_16x16x32_bf16 v[140:143], v[180:183], v[164:167], v[140:143]
  s_mov_b32 s27, 1490944
  s_add_u32 m0, s28, 40960
  s_nop 0
  buffer_load_dwordx4 v4, s[16:19], s27 offen lds
  ds_read_b64_tr_b16 v[216:217], v8 offset:53248
  ds_read_b64_tr_b16 v[218:219], v8 offset:53760
  v_mfma_f32_16x16x32_bf16 v[128:131], v[184:187], v[168:171], v[128:131]
  ds_read_b64_tr_b16 v[220:221], v9 offset:53248
  ds_read_b64_tr_b16 v[222:223], v9 offset:53760
  v_mfma_f32_16x16x32_bf16 v[132:135], v[188:191], v[168:171], v[132:135]
  s_mov_b32 s26, 3328
  s_add_u32 m0, s28, 33792
  s_nop 0
  buffer_load_dwordx4 v3, s[12:15], s26 offen lds
  v_mfma_f32_16x16x32_bf16 v[136:139], v[184:187], v[172:175], v[136:139]
  v_mfma_f32_16x16x32_bf16 v[140:143], v[188:191], v[172:175], v[140:143]
  s_mov_b32 s27, 1490944
  s_add_u32 m0, s28, 41984
  s_nop 0
  buffer_load_dwordx4 v5, s[16:19], s27 offen lds
  s_waitcnt vmcnt(8) lgkmcnt(0)
  s_barrier
  ds_read_b128 v[160:163], v6 offset:0
  ds_read_b128 v[164:167], v6 offset:2048
  v_mfma_f32_16x16x32_bf16 v[128:131], v[208:211], v[192:195], v[128:131]
  ds_read_b64_tr_b16 v[176:177], v8 offset:0
  ds_read_b64_tr_b16 v[178:179], v8 offset:512
  v_mfma_f32_16x16x32_bf16 v[132:135], v[212:215], v[192:195], v[132:135]
  s_mov_b32 s26, 3456
  s_add_u32 m0, s28, 49152
  s_nop 0
  buffer_load_dwordx4 v2, s[12:15], s26 offen lds
  ds_read_b64_tr_b16 v[180:181], v9 offset:0
  ds_read_b64_tr_b16 v[182:183], v9 offset:512
  v_mfma_f32_16x16x32_bf16 v[136:139], v[208:211], v[196:199], v[136:139]
  ds_read_b128 v[168:171], v7 offset:0
  ds_read_b128 v[172:175], v7 offset:2048
  v_mfma_f32_16x16x32_bf16 v[140:143], v[212:215], v[196:199], v[140:143]
  s_mov_b32 s27, 1548288
  s_add_u32 m0, s28, 57344
  s_nop 0
  buffer_load_dwordx4 v4, s[16:19], s27 offen lds
  ds_read_b64_tr_b16 v[184:185], v8 offset:4096
  ds_read_b64_tr_b16 v[186:187], v8 offset:4608
  v_mfma_f32_16x16x32_bf16 v[128:131], v[216:219], v[200:203], v[128:131]
  ds_read_b64_tr_b16 v[188:189], v9 offset:4096
  ds_read_b64_tr_b16 v[190:191], v9 offset:4608
  v_mfma_f32_16x16x32_bf16 v[132:135], v[220:223], v[200:203], v[132:135]
  s_mov_b32 s26, 3456
  s_add_u32 m0, s28, 50176
  s_nop 0
  buffer_load_dwordx4 v3, s[12:15], s26 offen lds
  v_mfma_f32_16x16x32_bf16 v[136:139], v[216:219], v[204:207], v[136:139]
  v_mfma_f32_16x16x32_bf16 v[140:143], v[220:223], v[204:207], v[140:143]
  s_mov_b32 s27, 1548288
  s_add_u32 m0, s28, 58368
  s_nop 0
  buffer_load_dwordx4 v5, s[16:19], s27 offen lds
  s_mov_b32 s27, 344064
  s_add_u32 m0, s28, 65536
  s_nop 0
  buffer_load_dwordx4 v4, s[48:51], s27 offen lds
  s_mov_b32 s27, 344064
  s_add_u32 m0, s28, 66560
  s_nop 0
  buffer_load_dwordx4 v5, s[48:51], s27 offen lds
  s_waitcnt vmcnt(8) lgkmcnt(0)
  s_barrier
  ds_read_b128 v[192:195], v6 offset:16384
  ds_read_b128 v[196:199], v6 offset:18432
  v_mfma_f32_16x16x32_bf16 v[128:131], v[176:179], v[160:163], v[128:131]
  ds_read_b64_tr_b16 v[208:209], v8 offset:16384
  ds_read_b64_tr_b16 v[210:211], v8 offset:16896
  v_mfma_f32_16x16x32_bf16 v[132:135], v[180:183], v[160:163], v[132:135]
  s_mov_b32 s27, 0
  s_add_u32 m0, s28, 0
  s_nop 0
  buffer_load_dwordx4 v4, s[48:51], s27 offen lds
  ds_read_b64_tr_b16 v[212:213], v9 offset:16384
  ds_read_b64_tr_b16 v[214:215], v9 offset:16896
  v_mfma_f32_16x16x32_bf16 v[136:139], v[176:179], v[164:167], v[136:139]
  ds_read_b128 v[200:203], v7 offset:16384
  ds_read_b128 v[204:207], v7 offset:18432
  v_mfma_f32_16x16x32_bf16 v[140:143], v[180:183], v[164:167], v[140:143]
  s_mov_b32 s27, 0
  s_add_u32 m0, s28, 1024
  s_nop 0
  buffer_load_dwordx4 v5, s[48:51], s27 offen lds
  ds_read_b64_tr_b16 v[216:217], v8 offset:20480
  ds_read_b64_tr_b16 v[218:219], v8 offset:20992
  v_mfma_f32_16x16x32_bf16 v[128:131], v[184:187], v[168:171], v[128:131]
  ds_read_b64_tr_b16 v[220:221], v9 offset:20480
  ds_read_b64_tr_b16 v[222:223], v9 offset:20992
  v_mfma_f32_16x16x32_bf16 v[132:135], v[188:191], v[168:171], v[132:135]
  s_mov_b32 s27, 57344
  s_add_u32 m0, s28, 8192
  s_nop 0
  buffer_load_dwordx4 v4, s[48:51], s27 offen lds
  v_mfma_f32_16x16x32_bf16 v[136:139], v[184:187], v[172:175], v[136:139]
  v_mfma_f32_16x16x32_bf16 v[140:143], v[188:191], v[172:175], v[140:143]
  s_mov_b32 s27, 57344
  s_add_u32 m0, s28, 9216
  s_nop 0
  buffer_load_dwordx4 v5, s[48:51], s27 offen lds
  s_waitcnt vmcnt(8) lgkmcnt(0)
  s_barrier
  ds_read_b128 v[160:163], v6 offset:32768
  ds_read_b128 v[164:167], v6 offset:34816
  v_mfma_f32_16x16x32_bf16 v[128:131], v[208:211], v[192:195], v[128:131]
  ds_read_b64_tr_b16 v[176:177], v8 offset:32768
  ds_read_b64_tr_b16 v[178:179], v8 offset:33280
  v_mfma_f32_16x16x32_bf16 v[132:135], v[212:215], v[192:195], v[132:135]
  s_mov_b32 s27, 114688
  s_add_u32 m0, s28, 16384
  s_nop 0
  buffer_load_dwordx4 v4, s[48:51], s27 offen lds
  ds_read_b64_tr_b16 v[180:181], v9 offset:32768
  ds_read_b64_tr_b16 v[182:183], v9 offset:33280
  v_mfma_f32_16x16x32_bf16 v[136:139], v[208:211], v[196:199], v[136:139]
  ds_read_b128 v[168:171], v7 offset:32768
  ds_read_b128 v[172:175], v7 offset:34816
  v_mfma_f32_16x16x32_bf16 v[140:143], v[212:215], v[196:199], v[140:143]
  s_mov_b32 s27, 114688
  s_add_u32 m0, s28, 17408
  s_nop 0
  buffer_load_dwordx4 v5, s[48:51], s27 offen lds
  ds_read_b64_tr_b16 v[184:185], v8 offset:36864
  ds_read_b64_tr_b16 v[186:187], v8 offset:37376
  v_mfma_f32_16x16x32_bf16 v[128:131], v[216:219], v[200:203], v[128:131]
  ds_read_b64_tr_b16 v[188:189], v9 offset:36864
  ds_read_b64_tr_b16 v[190:191], v9 offset:37376
  v_mfma_f32_16x16x32_bf16 v[132:135], v[220:223], v[200:203], v[132:135]
  s_mov_b32 s27, 172032
  s_add_u32 m0, s28, 24576
  s_nop 0
  buffer_load_dwordx4 v4, s[48:51], s27 offen lds
  v_mfma_f32_16x16x32_bf16 v[136:139], v[216:219], v[204:207], v[136:139]
  v_mfma_f32_16x16x32_bf16 v[140:143], v[220:223], v[204:207], v[140:143]
  s_mov_b32 s27, 172032
  s_add_u32 m0, s28, 25600
  s_nop 0
  buffer_load_dwordx4 v5, s[48:51], s27 offen lds
  buffer_load_dwordx4 v[24:27], v21, s[56:59], 0 offen sc1
  s_waitcnt vmcnt(8) lgkmcnt(0)
  s_barrier
  ds_read_b128 v[192:195], v6 offset:49152
  ds_read_b128 v[196:199], v6 offset:51200
  v_mfma_f32_16x16x32_bf16 v[128:131], v[176:179], v[160:163], v[128:131]
  ds_read_b64_tr_b16 v[208:209], v8 offset:49152
  ds_read_b64_tr_b16 v[210:211], v8 offset:49664
  v_mfma_f32_16x16x32_bf16 v[132:135], v[180:183], v[160:163], v[132:135]
  s_mov_b32 s27, 229376
  s_add_u32 m0, s28, 32768
  s_nop 0
  buffer_load_dwordx4 v4, s[48:51], s27 offen lds
  ds_read_b64_tr_b16 v[212:213], v9 offset:49152
  ds_read_b64_tr_b16 v[214:215], v9 offset:49664
  v_mfma_f32_16x16x32_bf16 v[136:139], v[176:179], v[164:167], v[136:139]
  ds_read_b128 v[200:203], v7 offset:49152
  ds_read_b128 v[204:207], v7 offset:51200
  v_mfma_f32_16x16x32_bf16 v[140:143], v[180:183], v[164:167], v[140:143]
  s_mov_b32 s27, 229376
  s_add_u32 m0, s28, 33792
  s_nop 0
  buffer_load_dwordx4 v5, s[48:51], s27 offen lds
  ds_read_b64_tr_b16 v[216:217], v8 offset:53248
  ds_read_b64_tr_b16 v[218:219], v8 offset:53760
  v_mfma_f32_16x16x32_bf16 v[128:131], v[184:187], v[168:171], v[128:131]
  ds_read_b64_tr_b16 v[220:221], v9 offset:53248
  ds_read_b64_tr_b16 v[222:223], v9 offset:53760
  v_mfma_f32_16x16x32_bf16 v[132:135], v[188:191], v[168:171], v[132:135]
  s_mov_b32 s27, 286720
  s_add_u32 m0, s28, 40960
  s_nop 0
  buffer_load_dwordx4 v4, s[48:51], s27 offen lds
  v_mfma_f32_16x16x32_bf16 v[136:139], v[184:187], v[172:175], v[136:139]
  v_mfma_f32_16x16x32_bf16 v[140:143], v[188:191], v[172:175], v[140:143]
  s_mov_b32 s27, 286720
  s_add_u32 m0, s28, 41984
  s_nop 0
  buffer_load_dwordx4 v5, s[48:51], s27 offen lds
  s_waitcnt lgkmcnt(0)
  v_mfma_f32_16x16x32_bf16 v[128:131], v[208:211], v[192:195], v[128:131]
  v_mfma_f32_16x16x32_bf16 v[132:135], v[212:215], v[192:195], v[132:135]
  v_mfma_f32_16x16x32_bf16 v[136:139], v[208:211], v[196:199], v[136:139]
  v_mfma_f32_16x16x32_bf16 v[140:143], v[212:215], v[196:199], v[140:143]
  v_mfma_f32_16x16x32_bf16 v[128:131], v[216:219], v[200:203], v[128:131]
  v_mfma_f32_16x16x32_bf16 v[132:135], v[220:223], v[200:203], v[132:135]
  v_mfma_f32_16x16x32_bf16 v[136:139], v[216:219], v[204:207], v[136:139]
  v_mfma_f32_16x16x32_bf16 v[140:143], v[220:223], v[204:207], v[140:143]
  v_subrev_u32 v8, 8192, v8
  v_add_u32 v18, 49152, v18
  v_add_u32 v28, 65536, v8
  v_subrev_u32 v9, 8192, v9
  v_add_u32 v19, 49152, v19
  v_add_u32 v29, 65536, v9
  s_mov_b32 s30, 0
  s_cmp_lg_u32 s8, 0
  s_cbranch_scc1 K2_GO
  s_waitcnt vmcnt(4)
K2_SPIN:
  v_and_b32 v24, v24, v25
  v_and_b32 v26, v26, v27
  v_and_b32 v24, v24, v26
  v_cmp_ne_u32 vcc, 0, v24
  s_nop 4
  s_cmp_eq_u64 vcc, -1
  s_cbranch_scc1 K2_GO
  s_add_u32 s30, s30, 1
  s_cmp_ge_u32 s30, 0x20000
  s_cbranch_scc1 K2_GO
  s_sleep 2
  buffer_load_dwordx4 v[24:27], v21, s[56:59], 0 offen sc1
  s_waitcnt vmcnt(0)
  s_branch K2_SPIN
K2_GO:
  s_barrier
  s_mov_b32 s26, 0
  s_add_u32 m0, s28, 49152
  s_nop 0
  buffer_load_dwordx4 v16, s[44:47], s26 offen lds
  s_add_u32 m0, s28, 50176
  s_nop 0
  buffer_load_dwordx4 v17, s[44:47], s26 offen lds
  s_mov_b32 s26, 262144
  s_add_u32 m0, s28, 57344
  s_nop 0
  buffer_load_dwordx4 v16, s[44:47], s26 offen lds
  s_add_u32 m0, s28, 58368
  s_nop 0
  buffer_load_dwordx4 v17, s[44:47], s26 offen lds
  s_mov_b32 s26, 524288
  s_add_u32 m0, s28, 73728
  s_nop 0
  buffer_load_dwordx4 v16, s[44:47], s26 offen lds
  s_add_u32 m0, s28, 74752
  s_nop 0
  buffer_load_dwordx4 v17, s[44:47], s26 offen lds
  s_waitcnt vmcnt(4)
  s_barrier
  ds_read_b64_tr_b16 v[160:161], v18 offset:0
  ds_read_b64_tr_b16 v[176:177], v8 offset:0
  ds_read_b64_tr_b16 v[162:163], v18 offset:512
  ds_read_b64_tr_b16 v[178:179], v8 offset:512
  ds_read_b64_tr_b16 v[164:165], v19 offset:0
  ds_read_b64_tr_b16 v[180:181], v9 offset:0
  ds_read_b64_tr_b16 v[166:167], v19 offset:512
  ds_read_b64_tr_b16 v[182:183], v9 offset:512
  ds_read_b64_tr_b16 v[168:169], v18 offset:4096
  ds_read_b64_tr_b16 v[184:185], v8 offset:4096
  ds_read_b64_tr_b16 v[170:171], v18 offset:4608
  ds_read_b64_tr_b16 v[186:187], v8 offset:4608
  ds_read_b64_tr_b16 v[172:173], v19 offset:4096
  ds_read_b64_tr_b16 v[188:189], v9 offset:4096
  ds_read_b64_tr_b16 v[174:175], v19 offset:4608
  ds_read_b64_tr_b16 v[190:191], v9 offset:4608
  s_waitcnt vmcnt(2) lgkmcnt(0)
  s_barrier
  s_mov_b32 s26, 786432
  s_add_u32 m0, s28, 49152
  s_nop 0
  buffer_load_dwordx4 v16, s[44:47], s26 offen lds
  s_add_u32 m0, s28, 50176
  s_nop 0
  buffer_load_dwordx4 v17, s[44:47], s26 offen lds
  ds_read_b64_tr_b16 v[192:193], v18 offset:8192
  ds_read_b64_tr_b16 v[208:209], v8 offset:8192
  v_mfma_f32_16x16x32_bf16 v[144:147], v[176:179], v[160:163], v[144:147]
  ds_read_b64_tr_b16 v[194:195], v18 offset:8704
  ds_read_b64_tr_b16 v[210:211], v8 offset:8704
  v_mfma_f32_16x16x32_bf16 v[148:151], v[180:183], v[160:163], v[148:151]
  ds_read_b64_tr_b16 v[196:197], v19 offset:8192
  ds_read_b64_tr_b16 v[212:213], v9 offset:8192
  v_mfma_f32_16x16x32_bf16 v[152:155], v[176:179], v[164:167], v[152:155]
  ds_read_b64_tr_b16 v[198:199], v19 offset:8704
  ds_read_b64_tr_b16 v[214:215], v9 offset:8704
  v_mfma_f32_16x16x32_bf16 v[156:159], v[180:183], v[164:167], v[156:159]
  ds_read_b64_tr_b16 v[200:201], v18 offset:12288
  ds_read_b64_tr_b16 v[216:217], v8 offset:12288
  v_mfma_f32_16x16x32_bf16 v[144:147], v[184:187], v[168:171], v[144:147]
  ds_read_b64_tr_b16 v[202:203], v18 offset:12800
  ds_read_b64_tr_b16 v[218:219], v8 offset:12800
  v_mfma_f32_16x16x32_bf16 v[148:151], v[188:191], v[168:171], v[148:151]
  ds_read_b64_tr_b16 v[204:205], v19 offset:12288
  ds_read_b64_tr_b16 v[220:221], v9 offset:12288
  v_mfma_f32_16x16x32_bf16 v[152:155], v[184:187], v[172:175], v[152:155]
  ds_read_b64_tr_b16 v[206:207], v19 offset:12800
  ds_read_b64_tr_b16 v[222:223], v9 offset:12800
  v_mfma_f32_16x16x32_bf16 v[156:159], v[188:191], v[172:175], v[156:159]
  s_waitcnt vmcnt(2) lgkmcnt(0)
  s_barrier
  s_mov_b32 s26, 1048576
  s_add_u32 m0, s28, 57344
  s_nop 0
  buffer_load_dwordx4 v16, s[44:47], s26 offen lds
  s_add_u32 m0, s28, 58368
  s_nop 0
  buffer_load_dwordx4 v17, s[44:47], s26 offen lds
  ds_read_b64_tr_b16 v[160:161], v18 offset:24576
  ds_read_b64_tr_b16 v[176:177], v8 offset:16384
  v_mfma_f32_16x16x32_bf16 v[144:147], v[208:211], v[192:195], v[144:147]
  ds_read_b64_tr_b16 v[162:163], v18 offset:25088
  ds_read_b64_tr_b16 v[178:179], v8 offset:16896
  v_mfma_f32_16x16x32_bf16 v[148:151], v[212:215], v[192:195], v[148:151]
  ds_read_b64_tr_b16 v[164:165], v19 offset:24576
  ds_read_b64_tr_b16 v[180:181], v9 offset:16384
  v_mfma_f32_16x16x32_bf16 v[152:155], v[208:211], v[196:199], v[152:155]
  ds_read_b64_tr_b16 v[166:167], v19 offset:25088
  ds_read_b64_tr_b16 v[182:183], v9 offset:16896
  v_mfma_f32_16x16x32_bf16 v[156:159], v[212:215], v[196:199], v[156:159]
  ds_read_b64_tr_b16 v[168:169], v18 offset:28672
  ds_read_b64_tr_b16 v[184:185], v8 offset:20480
  v_mfma_f32_16x16x32_bf16 v[144:147], v[216:219], v[200:203], v[144:147]
  ds_read_b64_tr_b16 v[170:171], v18 offset:29184
  ds_read_b64_tr_b16 v[186:187], v8 offset:20992
  v_mfma_f32_16x16x32_bf16 v[148:151], v[220:223], v[200:203], v[148:151]
  ds_read_b64_tr_b16 v[172:173], v19 offset:28672
  ds_read_b64_tr_b16 v[188:189], v9 offset:20480
  v_mfma_f32_16x16x32_bf16 v[152:155], v[216:219], v[204:207], v[152:155]
  ds_read_b64_tr_b16 v[174:175], v19 offset:29184
  ds_read_b64_tr_b16 v[190:191], v9 offset:20992
  v_mfma_f32_16x16x32_bf16 v[156:159], v[220:223], v[204:207], v[156:159]
  s_waitcnt vmcnt(2) lgkmcnt(0)
  s_barrier
  s_mov_b32 s26, 1310720
  s_add_u32 m0, s28, 73728
  s_nop 0
  buffer_load_dwordx4 v16, s[44:47], s26 offen lds
  s_add_u32 m0, s28, 74752
  s_nop 0
  buffer_load_dwordx4 v17, s[44:47], s26 offen lds
  ds_read_b64_tr_b16 v[192:193], v18 offset:0
  ds_read_b64_tr_b16 v[208:209], v8 offset:24576
  v_mfma_f32_16x16x32_bf16 v[144:147], v[176:179], v[160:163], v[144:147]
  ds_read_b64_tr_b16 v[194:195], v18 offset:512
  ds_read_b64_tr_b16 v[210:211], v8 offset:25088
  v_mfma_f32_16x16x32_bf16 v[148:151], v[180:183], v[160:163], v[148:151]
  ds_read_b64_tr_b16 v[196:197], v19 offset:0
  ds_read_b64_tr_b16 v[212:213], v9 offset:24576
  v_mfma_f32_16x16x32_bf16 v[152:155], v[176:179], v[164:167], v[152:155]
  ds_read_b64_tr_b16 v[198:199], v19 offset:512
  ds_read_b64_tr_b16 v[214:215], v9 offset:25088
  v_mfma_f32_16x16x32_bf16 v[156:159], v[180:183], v[164:167], v[156:159]
  ds_read_b64_tr_b16 v[200:201], v18 offset:4096
  ds_read_b64_tr_b16 v[216:217], v8 offset:28672
  v_mfma_f32_16x16x32_bf16 v[144:147], v[184:187], v[168:171], v[144:147]
  ds_read_b64_tr_b16 v[202:203], v18 offset:4608
  ds_read_b64_tr_b16 v[218:219], v8 offset:29184
  v_mfma_f32_16x16x32_bf16 v[148:151], v[188:191], v[168:171], v[148:151]
  ds_read_b64_tr_b16 v[204:205], v19 offset:4096
  ds_read_b64_tr_b16 v[220:221], v9 offset:28672
  v_mfma_f32_16x16x32_bf16 v[152:155], v[184:187], v[172:175], v[152:155]
  ds_read_b64_tr_b16 v[206:207], v19 offset:4608
  ds_read_b64_tr_b16 v[222:223], v9 offset:29184
  v_mfma_f32_16x16x32_bf16 v[156:159], v[188:191], v[172:175], v[156:159]
  s_waitcnt vmcnt(2) lgkmcnt(0)
  s_barrier
  s_mov_b32 s26, 1572864
  s_add_u32 m0, s28, 49152
  s_nop 0
  buffer_load_dwordx4 v16, s[44:47], s26 offen lds
  s_add_u32 m0, s28, 50176
  s_nop 0
  buffer_load_dwordx4 v17, s[44:47], s26 offen lds
  ds_read_b64_tr_b16 v[160:161], v18 offset:8192
  ds_read_b64_tr_b16 v[176:177], v8 offset:32768
  v_mfma_f32_16x16x32_bf16 v[144:147], v[208:211], v[192:195], v[144:147]
  ds_read_b64_tr_b16 v[162:163], v18 offset:8704
  ds_read_b64_tr_b16 v[178:179], v8 offset:33280
  v_mfma_f32_16x16x32_bf16 v[148:151], v[212:215], v[192:195], v[148:151]
  ds_read_b64_tr_b16 v[164:165], v19 offset:8192
  ds_read_b64_tr_b16 v[180:181], v9 offset:32768
  v_mfma_f32_16x16x32_bf16 v[152:155], v[208:211], v[196:199], v[152:155]
  ds_read_b64_tr_b16 v[166:167], v19 offset:8704
  ds_read_b64_tr_b16 v[182:183], v9 offset:33280
  v_mfma_f32_16x16x32_bf16 v[156:159], v[212:215], v[196:199], v[156:159]
  ds_read_b64_tr_b16 v[168:169], v18 offset:12288
  ds_read_b64_tr_b16 v[184:185], v8 offset:36864
  v_mfma_f32_16x16x32_bf16 v[144:147], v[216:219], v[200:203], v[144:147]
  ds_read_b64_tr_b16 v[170:171], v18 offset:12800
  ds_read_b64_tr_b16 v[186:187], v8 offset:37376
  v_mfma_f32_16x16x32_bf16 v[148:151], v[220:223], v[200:203], v[148:151]
  ds_read_b64_tr_b16 v[172:173], v19 offset:12288
  ds_read_b64_tr_b16 v[188:189], v9 offset:36864
  v_mfma_f32_16x16x32_bf16 v[152:155], v[216:219], v[204:207], v[152:155]
  ds_read_b64_tr_b16 v[174:175], v19 offset:12800
  ds_read_b64_tr_b16 v[190:191], v9 offset:37376
  v_mfma_f32_16x16x32_bf16 v[156:159], v[220:223], v[204:207], v[156:159]
  s_waitcnt vmcnt(2) lgkmcnt(0)
  s_barrier
  ds_read_b64_tr_b16 v[192:193], v18 offset:24576
  ds_read_b64_tr_b16 v[208:209], v8 offset:40960
  v_mfma_f32_16x16x32_bf16 v[144:147], v[176:179], v[160:163], v[144:147]
  ds_read_b64_tr_b16 v[194:195], v18 offset:25088
  ds_read_b64_tr_b16 v[210:211], v8 offset:41472
  v_mfma_f32_16x16x32_bf16 v[148:151], v[180:183], v[160:163], v[148:151]
  ds_read_b64_tr_b16 v[196:197], v19 offset:24576
  ds_read_b64_tr_b16 v[212:213], v9 offset:40960
  v_mfma_f32_16x16x32_bf16 v[152:155], v[176:179], v[164:167], v[152:155]
  ds_read_b64_tr_b16 v[198:199], v19 offset:25088
  ds_read_b64_tr_b16 v[214:215], v9 offset:41472
  v_mfma_f32_16x16x32_bf16 v[156:159], v[180:183], v[164:167], v[156:159]
  ds_read_b64_tr_b16 v[200:201], v18 offset:28672
  ds_read_b64_tr_b16 v[216:217], v8 offset:45056
  v_mfma_f32_16x16x32_bf16 v[144:147], v[184:187], v[168:171], v[144:147]
  ds_read_b64_tr_b16 v[202:203], v18 offset:29184
  ds_read_b64_tr_b16 v[218:219], v8 offset:45568
  v_mfma_f32_16x16x32_bf16 v[148:151], v[188:191], v[168:171], v[148:151]
  ds_read_b64_tr_b16 v[204:205], v19 offset:28672
  ds_read_b64_tr_b16 v[220:221], v9 offset:45056
  v_mfma_f32_16x16x32_bf16 v[152:155], v[184:187], v[172:175], v[152:155]
  ds_read_b64_tr_b16 v[206:207], v19 offset:29184
  ds_read_b64_tr_b16 v[222:223], v9 offset:45568
  v_mfma_f32_16x16x32_bf16 v[156:159], v[188:191], v[172:175], v[156:159]
  s_waitcnt vmcnt(0) lgkmcnt(0)
  s_barrier
  ds_read_b64_tr_b16 v[160:161], v18 offset:0
  ds_read_b64_tr_b16 v[176:177], v28 offset:0
  v_mfma_f32_16x16x32_bf16 v[144:147], v[208:211], v[192:195], v[144:147]
  ds_read_b64_tr_b16 v[162:163], v18 offset:512
  ds_read_b64_tr_b16 v[178:179], v28 offset:512
  v_mfma_f32_16x16x32_bf16 v[148:151], v[212:215], v[192:195], v[148:151]
  ds_read_b64_tr_b16 v[164:165], v19 offset:0
  ds_read_b64_tr_b16 v[180:181], v29 offset:0
  v_mfma_f32_16x16x32_bf16 v[152:155], v[208:211], v[196:199], v[152:155]
  ds_read_b64_tr_b16 v[166:167], v19 offset:512
  ds_read_b64_tr_b16 v[182:183], v29 offset:512
  v_mfma_f32_16x16x32_bf16 v[156:159], v[212:215], v[196:199], v[156:159]
  ds_read_b64_tr_b16 v[168:169], v18 offset:4096
  ds_read_b64_tr_b16 v[184:185], v28 offset:4096
  v_mfma_f32_16x16x32_bf16 v[144:147], v[216:219], v[200:203], v[144:147]
  ds_read_b64_tr_b16 v[170:171], v18 offset:4608
  ds_read_b64_tr_b16 v[186:187], v28 offset:4608
  v_mfma_f32_16x16x32_bf16 v[148:151], v[220:223], v[200:203], v[148:151]
  ds_read_b64_tr_b16 v[172:173], v19 offset:4096
  ds_read_b64_tr_b16 v[188:189], v29 offset:4096
  v_mfma_f32_16x16x32_bf16 v[152:155], v[216:219], v[204:207], v[152:155]
  ds_read_b64_tr_b16 v[174:175], v19 offset:4608
  ds_read_b64_tr_b16 v[190:191], v29 offset:4608
  v_mfma_f32_16x16x32_bf16 v[156:159], v[220:223], v[204:207], v[156:159]
  s_waitcnt lgkmcnt(0)
  v_mfma_f32_16x16x32_bf16 v[144:147], v[176:179], v[160:163], v[144:147]
  v_mfma_f32_16x16x32_bf16 v[148:151], v[180:183], v[160:163], v[148:151]
  v_mfma_f32_16x16x32_bf16 v[152:155], v[176:179], v[164:167], v[152:155]
  v_mfma_f32_16x16x32_bf16 v[156:159], v[180:183], v[164:167], v[156:159]
  v_mfma_f32_16x16x32_bf16 v[144:147], v[184:187], v[168:171], v[144:147]
  v_mfma_f32_16x16x32_bf16 v[148:151], v[188:191], v[168:171], v[148:151]
  v_mfma_f32_16x16x32_bf16 v[152:155], v[184:187], v[172:175], v[152:155]
  v_mfma_f32_16x16x32_bf16 v[156:159], v[188:191], v[172:175], v[156:159]
  v_and_b32 v13, 15, v1
  s_lshl_b32 s9, s24, 6
  s_lshr_b32 s10, s8, 1
  s_lshl_b32 s10, s10, 5
  s_add_u32 s9, s9, s10
  v_add_u32 v13, s9, v13
  v_mul_u32_u24 v13, 896, v13
  v_bfe_u32 v14, v1, 4, 1
  v_lshl_add_u32 v13, v14, 5, v13
  v_bfe_u32 v14, v1, 5, 1
  v_lshl_add_u32 v13, v14, 4, v13
  s_lshl_b32 s9, s25, 7
  s_and_b32 s10, s8, 1
  s_lshl_b32 s10, s10, 6
  s_add_u32 s9, s9, s10
  s_add_u32 s10, s9, 14336
  s_nop 4
  v_sub_f32 v30, 1.0, v22
  v_mul_f32 v128, v30, v128
  v_mul_f32 v129, v30, v129
  v_mul_f32 v130, v30, v130
  v_mul_f32 v131, v30, v131
  v_mul_f32 v132, v30, v132
  v_mul_f32 v133, v30, v133
  v_mul_f32 v134, v30, v134
  v_mul_f32 v135, v30, v135
  v_fma_f32 v144, v144, v22, v128
  v_fma_f32 v145, v145, v22, v129
  v_fma_f32 v146, v146, v22, v130
  v_fma_f32 v147, v147, v22, v131
  v_fma_f32 v148, v148, v22, v132
  v_fma_f32 v149, v149, v22, v133
  v_fma_f32 v150, v150, v22, v134
  v_fma_f32 v151, v151, v22, v135
  v_cvt_pk_bf16_f32 v160, v144, v145
  v_cvt_pk_bf16_f32 v161, v146, v147
  v_cvt_pk_bf16_f32 v162, v148, v149
  v_cvt_pk_bf16_f32 v163, v150, v151
  v_sub_f32 v31, 1.0, v23
  v_mul_f32 v136, v31, v136
  v_mul_f32 v137, v31, v137
  v_mul_f32 v138, v31, v138
  v_mul_f32 v139, v31, v139
  v_mul_f32 v140, v31, v140
  v_mul_f32 v141, v31, v141
  v_mul_f32 v142, v31, v142
  v_mul_f32 v143, v31, v143
  v_fma_f32 v152, v152, v23, v136
  v_fma_f32 v153, v153, v23, v137
  v_fma_f32 v154, v154, v23, v138
  v_fma_f32 v155, v155, v23, v139
  v_fma_f32 v156, v156, v23, v140
  v_fma_f32 v157, v157, v23, v141
  v_fma_f32 v158, v158, v23, v142
  v_fma_f32 v159, v159, v23, v143
  v_cvt_pk_bf16_f32 v164, v152, v153
  v_cvt_pk_bf16_f32 v165, v154, v155
  v_cvt_pk_bf16_f32 v166, v156, v157
  v_cvt_pk_bf16_f32 v167, v158, v159
  s_nop 1
  v_permlane16_swap_b32 v160, v162
  v_permlane16_swap_b32 v161, v163
  v_permlane16_swap_b32 v164, v166
  v_permlane16_swap_b32 v165, v167
  s_nop 1
  buffer_store_dwordx4 v[160:163], v13, s[20:23], s9 offen
  buffer_store_dwordx4 v[164:167], v13, s[20:23], s10 offen
K2_END:
  s_endpgm
.section .rodata,"a"
.p2align 6
.amdhsa_kernel k2_kernel
  .amdhsa_next_free_vgpr 224
  .amdhsa_next_free_sgpr 102
  .amdhsa_accum_offset 224
  .amdhsa_group_segment_fixed_size 0
  .amdhsa_kernarg_size 88
  .amdhsa_user_sgpr_count 2
  .amdhsa_user_sgpr_kernarg_segment_ptr 1
  .amdhsa_system_sgpr_workgroup_id_x 1
  .amdhsa_float_denorm_mode_32 3
.end_amdhsa_kernel
.altmacro
.set CF_0, 16256
.set SF_0, 32768
.set CG1_0, 13714
.set CG2_0, 13842
.set SG_0, 32768
.set CF_1, 16256
.set SF_1, 48230
.set CG1_1, 13714
.set CG2_1, 13842
.set SG_1, 45827
.set CF_2, 16256
.set SF_2, 48358
.set CG1_2, 13714
.set CG2_2, 13842
.set SG_2, 45955
.set CF_3, 16256
.set SF_3, 48428
.set CG1_3, 13714
.set CG2_3, 13842
.set SG_3, 46021
.set CF_4, 16256
.set SF_4, 48486
.set CG1_4, 13714
.set CG2_4, 13842
.set SG_4, 46083
.set CF_5, 16255
.set SF_5, 48527
.set CG1_5, 13714
.set CG2_5, 13842
.set SG_5, 46116
.set CF_6, 16255
.set SF_6, 48556
.set CG1_6, 13714
.set CG2_6, 13842
.set SG_6, 46149
.set CF_7, 16255
.set SF_7, 48585
.set CG1_7, 13714
.set CG2_7, 13842
.set SG_7, 46181
.set CF_8, 16254
.set SF_8, 48613
.set CG1_8, 13713
.set CG2_8, 13841
.set SG_8, 46211
.set CF_9, 16254
.set SF_9, 48641
.set CG1_9, 13713
.set CG2_9, 13841
.set SG_9, 46227
.set CF_10, 16253
.set SF_10, 48655
.set CG1_10, 13713
.set CG2_10, 13841
.set SG_10, 46244
.set CF_11, 16253
.set SF_11, 48669
.set CG1_11, 13713
.set CG2_11, 13841
.set SG_11, 46260
.set CF_12, 16252
.set SF_12, 48684
.set CG1_12, 13712
.set CG2_12, 13840
.set SG_12, 46276
.set CF_13, 16252
.set SF_13, 48698
.set CG1_13, 13712
.set CG2_13, 13840
.set SG_13, 46292
.set CF_14, 16251
.set SF_14, 48712
.set CG1_14, 13711
.set CG2_14, 13839
.set SG_14, 46308
.set CF_15, 16250
.set SF_15, 48726
.set CG1_15, 13711
.set CG2_15, 13839
.set SG_15, 46324
.set CF_16, 16250
.set SF_16, 48740
.set CG1_16, 13711
.set CG2_16, 13839
.set SG_16, 46338
.set CF_17, 16249
.set SF_17, 48754
.set CG1_17, 13710
.set CG2_17, 13838
.set SG_17, 46346
.set CF_18, 16248
.set SF_18, 48768
.set CG1_18, 13710
.set CG2_18, 13838
.set SG_18, 46354
.set CF_19, 16247
.set SF_19, 48775
.set CG1_19, 13709
.set CG2_19, 13837
.set SG_19, 46362
.set CF_20, 16246
.set SF_20, 48782
.set CG1_20, 13709
.set CG2_20, 13837
.set SG_20, 46370
.set CF_21, 16245
.set SF_21, 48789
.set CG1_21, 13708
.set CG2_21, 13836
.set SG_21, 46378
.set CF_22, 16244
.set SF_22, 48795
.set CG1_22, 13707
.set CG2_22, 13835
.set SG_22, 46386
.set CF_23, 16243
.set SF_23, 48802
.set CG1_23, 13707
.set CG2_23, 13835
.set SG_23, 46393
.set CF_24, 16242
.set SF_24, 48809
.set CG1_24, 13706
.set CG2_24, 13834
.set SG_24, 46401
.set CF_25, 16240
.set SF_25, 48816
.set CG1_25, 13705
.set CG2_25, 13833
.set SG_25, 46409
.set CF_26, 16239
.set SF_26, 48823
.set CG1_26, 13705
.set CG2_26, 13833
.set SG_26, 46417
.set CF_27, 16238
.set SF_27, 48829
.set CG1_27, 13704
.set CG2_27, 13832
.set SG_27, 46424
.set CF_28, 16237
.set SF_28, 48836
.set CG1_28, 13703
.set CG2_28, 13831
.set SG_28, 46432
.set CF_29, 16235
.set SF_29, 48843
.set CG1_29, 13702
.set CG2_29, 13830
.set SG_29, 46439
.set CF_30, 16234
.set SF_30, 48849
.set CG1_30, 13702
.set CG2_30, 13830
.set SG_30, 46447
.set CF_31, 16232
.set SF_31, 48856
.set CG1_31, 13701
.set CG2_31, 13829
.set SG_31, 46454
.set CF_32, 16231
.set SF_32, 48862
.set CG1_32, 13700
.set CG2_32, 13828
.set SG_32, 46462
.set CF_33, 16229
.set SF_33, 48869
.set CG1_33, 13699
.set CG2_33, 13827
.set SG_33, 46467
.set CF_34, 16227
.set SF_34, 48875
.set CG1_34, 13698
.set CG2_34, 13826
.set SG_34, 46470
.set CF_35, 16226
.set SF_35, 48881
.set CG1_35, 13697
.set CG2_35, 13825
.set SG_35, 46474
.set CF_36, 16224
.set SF_36, 48888
.set CG1_36, 13696
.set CG2_36, 13824
.set SG_36, 46478
.set CF_37, 16222
.set SF_37, 48894
.set CG1_37, 13694
.set CG2_37, 13822
.set SG_37, 46481
.set CF_38, 16220
.set SF_38, 48898
.set CG1_38, 13692
.set CG2_38, 13820
.set SG_38, 46485
.set CF_39, 16219
.set SF_39, 48901
.set CG1_39, 13690
.set CG2_39, 13818
.set SG_39, 46488
.set CF_40, 16217
.set SF_40, 48904
.set CG1_40, 13688
.set CG2_40, 13816
.set SG_40, 46492
.set CF_41, 16215
.set SF_41, 48907
.set CG1_41, 13686
.set CG2_41, 13814
.set SG_41, 46495
.set CF_42, 16213
.set SF_42, 48910
.set CG1_42, 13683
.set CG2_42, 13811
.set SG_42, 46499
.set CF_43, 16211
.set SF_43, 48913
.set CG1_43, 13681
.set CG2_43, 13809
.set SG_43, 46502
.set CF_44, 16209
.set SF_44, 48916
.set CG1_44, 13679
.set CG2_44, 13807
.set SG_44, 46505
.set CF_45, 16207
.set SF_45, 48919
.set CG1_45, 13676
.set CG2_45, 13804
.set SG_45, 46509
.set CF_46, 16205
.set SF_46, 48922
.set CG1_46, 13674
.set CG2_46, 13802
.set SG_46, 46512
.set CF_47, 16202
.set SF_47, 48925
.set CG1_47, 13671
.set CG2_47, 13799
.set SG_47, 46515
.set CF_48, 16200
.set SF_48, 48928
.set CG1_48, 13669
.set CG2_48, 13797
.set SG_48, 46518
.set CF_49, 16198
.set SF_49, 48930
.set CG1_49, 13666
.set CG2_49, 13794
.set SG_49, 46522
.set CF_50, 16196
.set SF_50, 48933
.set CG1_50, 13664
.set CG2_50, 13792
.set SG_50, 46525
.set CF_51, 16193
.set SF_51, 48936
.set CG1_51, 13661
.set CG2_51, 13789
.set SG_51, 46528
.set CF_52, 16191
.set SF_52, 48939
.set CG1_52, 13658
.set CG2_52, 13786
.set SG_52, 46531
.set CF_53, 16188
.set SF_53, 48941
.set CG1_53, 13655
.set CG2_53, 13783
.set SG_53, 46534
.set CF_54, 16186
.set SF_54, 48944
.set CG1_54, 13653
.set CG2_54, 13781
.set SG_54, 46537
.set CF_55, 16184
.set SF_55, 48946
.set CG1_55, 13650
.set CG2_55, 13778
.set SG_55, 46540
.set CF_56, 16181
.set SF_56, 48949
.set CG1_56, 13647
.set CG2_56, 13775
.set SG_56, 46543
.set CF_57, 16178
.set SF_57, 48952
.set CG1_57, 13644
.set CG2_57, 13772
.set SG_57, 46546
.set CF_58, 16176
.set SF_58, 48954
.set CG1_58, 13641
.set CG2_58, 13769
.set SG_58, 46549
.set CF_59, 16173
.set SF_59, 48956
.set CG1_59, 13638
.set CG2_59, 13766
.set SG_59, 46551
.set CF_60, 16171
.set SF_60, 48959
.set CG1_60, 13635
.set CG2_60, 13763
.set SG_60, 46554
.set CF_61, 16168
.set SF_61, 48961
.set CG1_61, 13632
.set CG2_61, 13760
.set SG_61, 46557
.set CF_62, 16165
.set SF_62, 48964
.set CG1_62, 13629
.set CG2_62, 13757
.set SG_62, 46560
.set CF_63, 16162
.set SF_63, 48966
.set CG1_63, 13626
.set CG2_63, 13754
.set SG_63, 46562
.set CF_64, 16160
.set SF_64, 48968
.set CG1_64, 13622
.set CG2_64, 13750
.set SG_64, 46565
.set CF_65, 16157
.set SF_65, 48970
.set CG1_65, 13619
.set CG2_65, 13747
.set SG_65, 46567
.set CF_66, 16154
.set SF_66, 48973
.set CG1_66, 13616
.set CG2_66, 13744
.set SG_66, 46570
.set CF_67, 16151
.set SF_67, 48975
.set CG1_67, 13613
.set CG2_67, 13741
.set SG_67, 46572
.set CF_68, 16148
.set SF_68, 48977
.set CG1_68, 13609
.set CG2_68, 13737
.set SG_68, 46575
.set CF_69, 16145
.set SF_69, 48979
.set CG1_69, 13606
.set CG2_69, 13734
.set SG_69, 46577
.set CF_70, 16142
.set SF_70, 48981
.set CG1_70, 13603
.set CG2_70, 13731
.set SG_70, 46579
.set CF_71, 16139
.set SF_71, 48983
.set CG1_71, 13599
.set CG2_71, 13727
.set SG_71, 46582
.set CF_72, 16136
.set SF_72, 48985
.set CG1_72, 13596
.set CG2_72, 13724
.set SG_72, 46584
.set CF_73, 16133
.set SF_73, 48987
.set CG1_73, 13592
.set CG2_73, 13720
.set SG_73, 46586
.set CF_74, 16130
.set SF_74, 48988
.set CG1_74, 13589
.set CG2_74, 13717
.set SG_74, 46588
.set CF_75, 16126
.set SF_75, 48990
.set CG1_75, 13585
.set CG2_75, 13713
.set SG_75, 46590
.set CF_76, 16120
.set SF_76, 48992
.set CG1_76, 13582
.set CG2_76, 13710
.set SG_76, 46592
.set CF_77, 16113
.set SF_77, 48994
.set CG1_77, 13578
.set CG2_77, 13706
.set SG_77, 46593
.set CF_78, 16107
.set SF_78, 48995
.set CG1_78, 13574
.set CG2_78, 13702
.set SG_78, 46594
.set CF_79, 16101
.set SF_79, 48997
.set CG1_79, 13571
.set CG2_79, 13699
.set SG_79, 46595
.set CF_80, 16094
.set SF_80, 48999
.set CG1_80, 13566
.set CG2_80, 13694
.set SG_80, 46596
.set CF_81, 16088
.set SF_81, 49000
.set CG1_81, 13558
.set CG2_81, 13686
.set SG_81, 46597
.set CF_82, 16081
.set SF_82, 49002
.set CG1_82, 13551
.set CG2_82, 13679
.set SG_82, 46598
.set CF_83, 16075
.set SF_83, 49003
.set CG1_83, 13543
.set CG2_83, 13671
.set SG_83, 46598
.set CF_84, 16068
.set SF_84, 49005
.set CG1_84, 13536
.set CG2_84, 13664
.set SG_84, 46599
.set CF_85, 16061
.set SF_85, 49006
.set CG1_85, 13528
.set CG2_85, 13656
.set SG_85, 46600
.set CF_86, 16055
.set SF_86, 49007
.set CG1_86, 13521
.set CG2_86, 13649
.set SG_86, 46601
.set CF_87, 16048
.set SF_87, 49008
.set CG1_87, 13513
.set CG2_87, 13641
.set SG_87, 46601
.set CF_88, 16041
.set SF_88, 49010
.set CG1_88, 13505
.set CG2_88, 13633
.set SG_88, 46602
.set CF_89, 16034
.set SF_89, 49011
.set CG1_89, 13497
.set CG2_89, 13625
.set SG_89, 46603
.set CF_90, 16027
.set SF_90, 49012
.set CG1_90, 13490
.set CG2_90, 13618
.set SG_90, 46603
.set CF_91, 16021
.set SF_91, 49013
.set CG1_91, 13482
.set CG2_91, 13610
.set SG_91, 46604
.set CF_92, 16014
.set SF_92, 49014
.set CG1_92, 13474
.set CG2_92, 13602
.set SG_92, 46605
.set CF_93, 16007
.set SF_93, 49015
.set CG1_93, 13466
.set CG2_93, 13594
.set SG_93, 46605
.set CF_94, 16000
.set SF_94, 49016
.set CG1_94, 13458
.set CG2_94, 13586
.set SG_94, 46606
.set CF_95, 15986
.set SF_95, 49017
.set CG1_95, 13450
.set CG2_95, 13578
.set SG_95, 46606
.set CF_96, 15972
.set SF_96, 49018
.set CG1_96, 13442
.set CG2_96, 13570
.set SG_96, 46607
.set CF_97, 15958
.set SF_97, 49018
.set CG1_97, 13428
.set CG2_97, 13556
.set SG_97, 46607
.set CF_98, 15944
.set SF_98, 49019
.set CG1_98, 13412
.set CG2_98, 13540
.set SG_98, 46607
.set CF_99, 15930
.set SF_99, 49020
.set CG1_99, 13396
.set CG2_99, 13524
.set SG_99, 46608
.set CF_100, 15916
.set SF_100, 49020
.set CG1_100, 13380
.set CG2_100, 13508
.set SG_100, 46608
.set CF_101, 15901
.set SF_101, 49021
.set CG1_101, 13364
.set CG2_101, 13492
.set SG_101, 46609
.set CF_102, 15887
.set SF_102, 49021
.set CG1_102, 13348
.set CG2_102, 13476
.set SG_102, 46609
.set CF_103, 15873
.set SF_103, 49022
.set CG1_103, 13331
.set CG2_103, 13459
.set SG_103, 46609
.set CF_104, 15845
.set SF_104, 49022
.set CG1_104, 13315
.set CG2_104, 13443
.set SG_104, 46609
.set CF_105, 15817
.set SF_105, 49023
.set CG1_105, 13285
.set CG2_105, 13413
.set SG_105, 46610
.set CF_106, 15788
.set SF_106, 49023
.set CG1_106, 13253
.set CG2_106, 13381
.set SG_106, 46610
.set CF_107, 15759
.set SF_107, 49023
.set CG1_107, 13220
.set CG2_107, 13348
.set SG_107, 46610
.set CF_108, 15718
.set SF_108, 49024
.set CG1_108, 13187
.set CG2_108, 13315
.set SG_108, 46610
.set CF_109, 15660
.set SF_109, 49024
.set CG1_109, 13125
.set CG2_109, 13253
.set SG_109, 46610
.set CF_110, 15590
.set SF_110, 49024
.set CG1_110, 13059
.set CG2_110, 13187
.set SG_110, 46610
.set CF_111, 15462
.set SF_111, 49024
.set CG1_111, 12931
.set CG2_111, 13059
.set SG_111, 46610
.set CF_112, 0
.set SF_112, 49024
.set CG1_112, 0
.set CG2_112, 0
.set SG_112, 46610
.set CF_113, 48230
.set SF_113, 49024
.set CG1_113, 45699
.set CG2_113, 45827
.set SG_113, 46610
.set CF_114, 48358
.set SF_114, 49024
.set CG1_114, 45827
.set CG2_114, 45955
.set SG_114, 46610
.set CF_115, 48428
.set SF_115, 49024
.set CG1_115, 45893
.set CG2_115, 46021
.set SG_115, 46610
.set CF_116, 48486
.set SF_116, 49024
.set CG1_116, 45955
.set CG2_116, 46083
.set SG_116, 46610
.set CF_117, 48527
.set SF_117, 49023
.set CG1_117, 45988
.set CG2_117, 46116
.set SG_117, 46610
.set CF_118, 48556
.set SF_118, 49023
.set CG1_118, 46021
.set CG2_118, 46149
.set SG_118, 46610
.set CF_119, 48585
.set SF_119, 49023
.set CG1_119, 46053
.set CG2_119, 46181
.set SG_119, 46610
.set CF_120, 48613
.set SF_120, 49022
.set CG1_120, 46083
.set CG2_120, 46211
.set SG_120, 46609
.set CF_121, 48641
.set SF_121, 49022
.set CG1_121, 46099
.set CG2_121, 46227
.set SG_121, 46609
.set CF_122, 48655
.set SF_122, 49021
.set CG1_122, 46116
.set CG2_122, 46244
.set SG_122, 46609
.set CF_123, 48669
.set SF_123, 49021
.set CG1_123, 46132
.set CG2_123, 46260
.set SG_123, 46609
.set CF_124, 48684
.set SF_124, 49020
.set CG1_124, 46148
.set CG2_124, 46276
.set SG_124, 46608
.set CF_125, 48698
.set SF_125, 49020
.set CG1_125, 46164
.set CG2_125, 46292
.set SG_125, 46608
.set CF_126, 48712
.set SF_126, 49019
.set CG1_126, 46180
.set CG2_126, 46308
.set SG_126, 46607
.set CF_127, 48726
.set SF_127, 49018
.set CG1_127, 46196
.set CG2_127, 46324
.set SG_127, 46607
.set CF_128, 48740
.set SF_128, 49018
.set CG1_128, 46210
.set CG2_128, 46338
.set SG_128, 46607
.set CF_129, 48754
.set SF_129, 49017
.set CG1_129, 46218
.set CG2_129, 46346
.set SG_129, 46606
.set CF_130, 48768
.set SF_130, 49016
.set CG1_130, 46226
.set CG2_130, 46354
.set SG_130, 46606
.set CF_131, 48775
.set SF_131, 49015
.set CG1_131, 46234
.set CG2_131, 46362
.set SG_131, 46605
.set CF_132, 48782
.set SF_132, 49014
.set CG1_132, 46242
.set CG2_132, 46370
.set SG_132, 46605
.set CF_133, 48789
.set SF_133, 49013
.set CG1_133, 46250
.set CG2_133, 46378
.set SG_133, 46604
.set CF_134, 48795
.set SF_134, 49012
.set CG1_134, 46258
.set CG2_134, 46386
.set SG_134, 46603
.set CF_135, 48802
.set SF_135, 49011
.set CG1_135, 46265
.set CG2_135, 46393
.set SG_135, 46603
.set CF_136, 48809
.set SF_136, 49010
.set CG1_136, 46273
.set CG2_136, 46401
.set SG_136, 46602
.set CF_137, 48816
.set SF_137, 49008
.set CG1_137, 46281
.set CG2_137, 46409
.set SG_137, 46601
.set CF_138, 48823
.set SF_138, 49007
.set CG1_138, 46289
.set CG2_138, 46417
.set SG_138, 46601
.set CF_139, 48829
.set SF_139, 49006
.set CG1_139, 46296
.set CG2_139, 46424
.set SG_139, 46600
.set CF_140, 48836
.set SF_140, 49005
.set CG1_140, 46304
.set CG2_140, 46432
.set SG_140, 46599
.set CF_141, 48843
.set SF_141, 49003
.set CG1_141, 46311
.set CG2_141, 46439
.set SG_141, 46598
.set CF_142, 48849
.set SF_142, 49002
.set CG1_142, 46319
.set CG2_142, 46447
.set SG_142, 46598
.set CF_143, 48856
.set SF_143, 49000
.set CG1_143, 46326
.set CG2_143, 46454
.set SG_143, 46597
.set CF_144, 48862
.set SF_144, 48999
.set CG1_144, 46334
.set CG2_144, 46462
.set SG_144, 46596
.set CF_145, 48869
.set SF_145, 48997
.set CG1_145, 46339
.set CG2_145, 46467
.set SG_145, 46595
.set CF_146, 48875
.set SF_146, 48995
.set CG1_146, 46342
.set CG2_146, 46470
.set SG_146, 46594
.set CF_147, 48881
.set SF_147, 48994
.set CG1_147, 46346
.set CG2_147, 46474
.set SG_147, 46593
.set CF_148, 48888
.set SF_148, 48992
.set CG1_148, 46350
.set CG2_148, 46478
.set SG_148, 46592
.set CF_149, 48894
.set SF_149, 48990
.set CG1_149, 46353
.set CG2_149, 46481
.set SG_149, 46590
.set CF_150, 48898
.set SF_150, 48988
.set CG1_150, 46357
.set CG2_150, 46485
.set SG_150, 46588
.set CF_151, 48901
.set SF_151, 48987
.set CG1_151, 46360
.set CG2_151, 46488
.set SG_151, 46586
.set CF_152, 48904
.set SF_152, 48985
.set CG1_152, 46364
.set CG2_152, 46492
.set SG_152, 46584
.set CF_153, 48907
.set SF_153, 48983
.set CG1_153, 46367
.set CG2_153, 46495
.set SG_153, 46582
.set CF_154, 48910
.set SF_154, 48981
.set CG1_154, 46371
.set CG2_154, 46499
.set SG_154, 46579
.set CF_155, 48913
.set SF_155, 48979
.set CG1_155, 46374
.set CG2_155, 46502
.set SG_155, 46577
.set CF_156, 48916
.set SF_156, 48977
.set CG1_156, 46377
.set CG2_156, 46505
.set SG_156, 46575
.set CF_157, 48919
.set SF_157, 48975
.set CG1_157, 46381
.set CG2_157, 46509
.set SG_157, 46572
.set CF_158, 48922
.set SF_158, 48973
.set CG1_158, 46384
.set CG2_158, 46512
.set SG_158, 46570
.set CF_159, 48925
.set SF_159, 48970
.set CG1_159, 46387
.set CG2_159, 46515
.set SG_159, 46567
.set CF_160, 48928
.set SF_160, 48968
.set CG1_160, 46390
.set CG2_160, 46518
.set SG_160, 46565
.set CF_161, 48930
.set SF_161, 48966
.set CG1_161, 46394
.set CG2_161, 46522
.set SG_161, 46562
.set CF_162, 48933
.set SF_162, 48964
.set CG1_162, 46397
.set CG2_162, 46525
.set SG_162, 46560
.set CF_163, 48936
.set SF_163, 48961
.set CG1_163, 46400
.set CG2_163, 46528
.set SG_163, 46557
.set CF_164, 48939
.set SF_164, 48959
.set CG1_164, 46403
.set CG2_164, 46531
.set SG_164, 46554
.set CF_165, 48941
.set SF_165, 48956
.set CG1_165, 46406
.set CG2_165, 46534
.set SG_165, 46551
.set CF_166, 48944
.set SF_166, 48954
.set CG1_166, 46409
.set CG2_166, 46537
.set SG_166, 46549
.set CF_167, 48946
.set SF_167, 48952
.set CG1_167, 46412
.set CG2_167, 46540
.set SG_167, 46546
.set CF_168, 48949
.set SF_168, 48949
.set CG1_168, 46415
.set CG2_168, 46543
.set SG_168, 46543
.set CF_169, 48952
.set SF_169, 48946
.set CG1_169, 46418
.set CG2_169, 46546
.set SG_169, 46540
.set CF_170, 48954
.set SF_170, 48944
.set CG1_170, 46421
.set CG2_170, 46549
.set SG_170, 46537
.set CF_171, 48956
.set SF_171, 48941
.set CG1_171, 46423
.set CG2_171, 46551
.set SG_171, 46534
.set CF_172, 48959
.set SF_172, 48939
.set CG1_172, 46426
.set CG2_172, 46554
.set SG_172, 46531
.set CF_173, 48961
.set SF_173, 48936
.set CG1_173, 46429
.set CG2_173, 46557
.set SG_173, 46528
.set CF_174, 48964
.set SF_174, 48933
.set CG1_174, 46432
.set CG2_174, 46560
.set SG_174, 46525
.set CF_175, 48966
.set SF_175, 48930
.set CG1_175, 46434
.set CG2_175, 46562
.set SG_175, 46522
.set CF_176, 48968
.set SF_176, 48928
.set CG1_176, 46437
.set CG2_176, 46565
.set SG_176, 46518
.set CF_177, 48970
.set SF_177, 48925
.set CG1_177, 46439
.set CG2_177, 46567
.set SG_177, 46515
.set CF_178, 48973
.set SF_178, 48922
.set CG1_178, 46442
.set CG2_178, 46570
.set SG_178, 46512
.set CF_179, 48975
.set SF_179, 48919
.set CG1_179, 46444
.set CG2_179, 46572
.set SG_179, 46509
.set CF_180, 48977
.set SF_180, 48916
.set CG1_180, 46447
.set CG2_180, 46575
.set SG_180, 46505
.set CF_181, 48979
.set SF_181, 48913
.set CG1_181, 46449
.set CG2_181, 46577
.set SG_181, 46502
.set CF_182, 48981
.set SF_182, 48910
.set CG1_182, 46451
.set CG2_182, 46579
.set SG_182, 46499
.set CF_183, 48983
.set SF_183, 48907
.set CG1_183, 46454
.set CG2_183, 46582
.set SG_183, 46495
.set CF_184, 48985
.set SF_184, 48904
.set CG1_184, 46456
.set CG2_184, 46584
.set SG_184, 46492
.set CF_185, 48987
.set SF_185, 48901
.set CG1_185, 46458
.set CG2_185, 46586
.set SG_185, 46488
.set CF_186, 48988
.set SF_186, 48898
.set CG1_186, 46460
.set CG2_186, 46588
.set SG_186, 46485
.set CF_187, 48990
.set SF_187, 48894
.set CG1_187, 46462
.set CG2_187, 46590
.set SG_187, 46481
.set CF_188, 48992
.set SF_188, 48888
.set CG1_188, 46464
.set CG2_188, 46592
.set SG_188, 46478
.set CF_189, 48994
.set SF_189, 48881
.set CG1_189, 46465
.set CG2_189, 46593
.set SG_189, 46474
.set CF_190, 48995
.set SF_190, 48875
.set CG1_190, 46466
.set CG2_190, 46594
.set SG_190, 46470
.set CF_191, 48997
.set SF_191, 48869
.set CG1_191, 46467
.set CG2_191, 46595
.set SG_191, 46467
.set CF_192, 48999
.set SF_192, 48862
.set CG1_192, 46468
.set CG2_192, 46596
.set SG_192, 46462
.set CF_193, 49000
.set SF_193, 48856
.set CG1_193, 46469
.set CG2_193, 46597
.set SG_193, 46454
.set CF_194, 49002
.set SF_194, 48849
.set CG1_194, 46470
.set CG2_194, 46598
.set SG_194, 46447
.set CF_195, 49003
.set SF_195, 48843
.set CG1_195, 46470
.set CG2_195, 46598
.set SG_195, 46439
.set CF_196, 49005
.set SF_196, 48836
.set CG1_196, 46471
.set CG2_196, 46599
.set SG_196, 46432
.set CF_197, 49006
.set SF_197, 48829
.set CG1_197, 46472
.set CG2_197, 46600
.set SG_197, 46424
.set CF_198, 49007
.set SF_198, 48823
.set CG1_198, 46473
.set CG2_198, 46601
.set SG_198, 46417
.set CF_199, 49008
.set SF_199, 48816
.set CG1_199, 46473
.set CG2_199, 46601
.set SG_199, 46409
.set CF_200, 49010
.set SF_200, 48809
.set CG1_200, 46474
.set CG2_200, 46602
.set SG_200, 46401
.set CF_201, 49011
.set SF_201, 48802
.set CG1_201, 46475
.set CG2_201, 46603
.set SG_201, 46393
.set CF_202, 49012
.set SF_202, 48795
.set CG1_202, 46475
.set CG2_202, 46603
.set SG_202, 46386
.set CF_203, 49013
.set SF_203, 48789
.set CG1_203, 46476
.set CG2_203, 46604
.set SG_203, 46378
.set CF_204, 49014
.set SF_204, 48782
.set CG1_204, 46477
.set CG2_204, 46605
.set SG_204, 46370
.set CF_205, 49015
.set SF_205, 48775
.set CG1_205, 46477
.set CG2_205, 46605
.set SG_205, 46362
.set CF_206, 49016
.set SF_206, 48768
.set CG1_206, 46478
.set CG2_206, 46606
.set SG_206, 46354
.set CF_207, 49017
.set SF_207, 48754
.set CG1_207, 46478
.set CG2_207, 46606
.set SG_207, 46346
.set CF_208, 49018
.set SF_208, 48740
.set CG1_208, 46479
.set CG2_208, 46607
.set SG_208, 46338
.set CF_209, 49018
.set SF_209, 48726
.set CG1_209, 46479
.set CG2_209, 46607
.set SG_209, 46324
.set CF_210, 49019
.set SF_210, 48712
.set CG1_210, 46479
.set CG2_210, 46607
.set SG_210, 46308
.set CF_211, 49020
.set SF_211, 48698
.set CG1_211, 46480
.set CG2_211, 46608
.set SG_211, 46292
.set CF_212, 49020
.set SF_212, 48684
.set CG1_212, 46480
.set CG2_212, 46608
.set SG_212, 46276
.set CF_213, 49021
.set SF_213, 48669
.set CG1_213, 46481
.set CG2_213, 46609
.set SG_213, 46260
.set CF_214, 49021
.set SF_214, 48655
.set CG1_214, 46481
.set CG2_214, 46609
.set SG_214, 46244
.set CF_215, 49022
.set SF_215, 48641
.set CG1_215, 46481
.set CG2_215, 46609
.set SG_215, 46227
.set CF_216, 49022
.set SF_216, 48613
.set CG1_216, 46481
.set CG2_216, 46609
.set SG_216, 46211
.set CF_217, 49023
.set SF_217, 48585
.set CG1_217, 46482
.set CG2_217, 46610
.set SG_217, 46181
.set CF_218, 49023
.set SF_218, 48556
.set CG1_218, 46482
.set CG2_218, 46610
.set SG_218, 46149
.set CF_219, 49023
.set SF_219, 48527
.set CG1_219, 46482
.set CG2_219, 46610
.set SG_219, 46116
.set CF_220, 49024
.set SF_220, 48486
.set CG1_220, 46482
.set CG2_220, 46610
.set SG_220, 46083
.set CF_221, 49024
.set SF_221, 48428
.set CG1_221, 46482
.set CG2_221, 46610
.set SG_221, 46021
.set CF_222, 49024
.set SF_222, 48358
.set CG1_222, 46482
.set CG2_222, 46610
.set SG_222, 45955
.set CF_223, 49024
.set SF_223, 48230
.set CG1_223, 46482
.set CG2_223, 46610
.set SG_223, 45827
.set CF_224, 49024
.set SF_224, 32768
.set CG1_224, 46482
.set CG2_224, 46610
.set SG_224, 32768
.set CF_225, 49024
.set SF_225, 15462
.set CG1_225, 46482
.set CG2_225, 46610
.set SG_225, 13059
.set CF_226, 49024
.set SF_226, 15590
.set CG1_226, 46482
.set CG2_226, 46610
.set SG_226, 13187
.set CF_227, 49024
.set SF_227, 15660
.set CG1_227, 46482
.set CG2_227, 46610
.set SG_227, 13253
.set CF_228, 49024
.set SF_228, 15718
.set CG1_228, 46482
.set CG2_228, 46610
.set SG_228, 13315
.set CF_229, 49023
.set SF_229, 15759
.set CG1_229, 46482
.set CG2_229, 46610
.set SG_229, 13348
.set CF_230, 49023
.set SF_230, 15788
.set CG1_230, 46482
.set CG2_230, 46610
.set SG_230, 13381
.set CF_231, 49023
.set SF_231, 15817
.set CG1_231, 46482
.set CG2_231, 46610
.set SG_231, 13413
.set CF_232, 49022
.set SF_232, 15845
.set CG1_232, 46481
.set CG2_232, 46609
.set SG_232, 13443
.set CF_233, 49022
.set SF_233, 15873
.set CG1_233, 46481
.set CG2_233, 46609
.set SG_233, 13459
.set CF_234, 49021
.set SF_234, 15887
.set CG1_234, 46481
.set CG2_234, 46609
.set SG_234, 13476
.set CF_235, 49021
.set SF_235, 15901
.set CG1_235, 46481
.set CG2_235, 46609
.set SG_235, 13492
.set CF_236, 49020
.set SF_236, 15916
.set CG1_236, 46480
.set CG2_236, 46608
.set SG_236, 13508
.set CF_237, 49020
.set SF_237, 15930
.set CG1_237, 46480
.set CG2_237, 46608
.set SG_237, 13524
.set CF_238, 49019
.set SF_238, 15944
.set CG1_238, 46479
.set CG2_238, 46607
.set SG_238, 13540
.set CF_239, 49018
.set SF_239, 15958
.set CG1_239, 46479
.set CG2_239, 46607
.set SG_239, 13556
.set CF_240, 49018
.set SF_240, 15972
.set CG1_240, 46479
.set CG2_240, 46607
.set SG_240, 13570
.set CF_241, 49017
.set SF_241, 15986
.set CG1_241, 46478
.set CG2_241, 46606
.set SG_241, 13578
.set CF_242, 49016
.set SF_242, 16000
.set CG1_242, 46478
.set CG2_242, 46606
.set SG_242, 13586
.set CF_243, 49015
.set SF_243, 16007
.set CG1_243, 46477
.set CG2_243, 46605
.set SG_243, 13594
.set CF_244, 49014
.set SF_244, 16014
.set CG1_244, 46477
.set CG2_244, 46605
.set SG_244, 13602
.set CF_245, 49013
.set SF_245, 16021
.set CG1_245, 46476
.set CG2_245, 46604
.set SG_245, 13610
.set CF_246, 49012
.set SF_246, 16027
.set CG1_246, 46475
.set CG2_246, 46603
.set SG_246, 13618
.set CF_247, 49011
.set SF_247, 16034
.set CG1_247, 46475
.set CG2_247, 46603
.set SG_247, 13625
.set CF_248, 49010
.set SF_248, 16041
.set CG1_248, 46474
.set CG2_248, 46602
.set SG_248, 13633
.set CF_249, 49008
.set SF_249, 16048
.set CG1_249, 46473
.set CG2_249, 46601
.set SG_249, 13641
.set CF_250, 49007
.set SF_250, 16055
.set CG1_250, 46473
.set CG2_250, 46601
.set SG_250, 13649
.set CF_251, 49006
.set SF_251, 16061
.set CG1_251, 46472
.set CG2_251, 46600
.set SG_251, 13656
.set CF_252, 49005
.set SF_252, 16068
.set CG1_252, 46471
.set CG2_252, 46599
.set SG_252, 13664
.set CF_253, 49003
.set SF_253, 16075
.set CG1_253, 46470
.set CG2_253, 46598
.set SG_253, 13671
.set CF_254, 49002
.set SF_254, 16081
.set CG1_254, 46470
.set CG2_254, 46598
.set SG_254, 13679
.set CF_255, 49000
.set SF_255, 16088
.set CG1_255, 46469
.set CG2_255, 46597
.set SG_255, 13686
.set CF_256, 48999
.set SF_256, 16094
.set CG1_256, 46468
.set CG2_256, 46596
.set SG_256, 13694
.set CF_257, 48997
.set SF_257, 16101
.set CG1_257, 46467
.set CG2_257, 46595
.set SG_257, 13699
.set CF_258, 48995
.set SF_258, 16107
.set CG1_258, 46466
.set CG2_258, 46594
.set SG_258, 13702
.set CF_259, 48994
.set SF_259, 16113
.set CG1_259, 46465
.set CG2_259, 46593
.set SG_259, 13706
.set CF_260, 48992
.set SF_260, 16120
.set CG1_260, 46464
.set CG2_260, 46592
.set SG_260, 13710
.set CF_261, 48990
.set SF_261, 16126
.set CG1_261, 46462
.set CG2_261, 46590
.set SG_261, 13713
.set CF_262, 48988
.set SF_262, 16130
.set CG1_262, 46460
.set CG2_262, 46588
.set SG_262, 13717
.set CF_263, 48987
.set SF_263, 16133
.set CG1_263, 46458
.set CG2_263, 46586
.set SG_263, 13720
.set CF_264, 48985
.set SF_264, 16136
.set CG1_264, 46456
.set CG2_264, 46584
.set SG_264, 13724
.set CF_265, 48983
.set SF_265, 16139
.set CG1_265, 46454
.set CG2_265, 46582
.set SG_265, 13727
.set CF_266, 48981
.set SF_266, 16142
.set CG1_266, 46451
.set CG2_266, 46579
.set SG_266, 13731
.set CF_267, 48979
.set SF_267, 16145
.set CG1_267, 46449
.set CG2_267, 46577
.set SG_267, 13734
.set CF_268, 48977
.set SF_268, 16148
.set CG1_268, 46447
.set CG2_268, 46575
.set SG_268, 13737
.set CF_269, 48975
.set SF_269, 16151
.set CG1_269, 46444
.set CG2_269, 46572
.set SG_269, 13741
.set CF_270, 48973
.set SF_270, 16154
.set CG1_270, 46442
.set CG2_270, 46570
.set SG_270, 13744
.set CF_271, 48970
.set SF_271, 16157
.set CG1_271, 46439
.set CG2_271, 46567
.set SG_271, 13747
.set CF_272, 48968
.set SF_272, 16160
.set CG1_272, 46437
.set CG2_272, 46565
.set SG_272, 13750
.set CF_273, 48966
.set SF_273, 16162
.set CG1_273, 46434
.set CG2_273, 46562
.set SG_273, 13754
.set CF_274, 48964
.set SF_274, 16165
.set CG1_274, 46432
.set CG2_274, 46560
.set SG_274, 13757
.set CF_275, 48961
.set SF_275, 16168
.set CG1_275, 46429
.set CG2_275, 46557
.set SG_275, 13760
.set CF_276, 48959
.set SF_276, 16171
.set CG1_276, 46426
.set CG2_276, 46554
.set SG_276, 13763
.set CF_277, 48956
.set SF_277, 16173
.set CG1_277, 46423
.set CG2_277, 46551
.set SG_277, 13766
.set CF_278, 48954
.set SF_278, 16176
.set CG1_278, 46421
.set CG2_278, 46549
.set SG_278, 13769
.set CF_279, 48952
.set SF_279, 16178
.set CG1_279, 46418
.set CG2_279, 46546
.set SG_279, 13772
.set CF_280, 48949
.set SF_280, 16181
.set CG1_280, 46415
.set CG2_280, 46543
.set SG_280, 13775
.set CF_281, 48946
.set SF_281, 16184
.set CG1_281, 46412
.set CG2_281, 46540
.set SG_281, 13778
.set CF_282, 48944
.set SF_282, 16186
.set CG1_282, 46409
.set CG2_282, 46537
.set SG_282, 13781
.set CF_283, 48941
.set SF_283, 16188
.set CG1_283, 46406
.set CG2_283, 46534
.set SG_283, 13783
.set CF_284, 48939
.set SF_284, 16191
.set CG1_284, 46403
.set CG2_284, 46531
.set SG_284, 13786
.set CF_285, 48936
.set SF_285, 16193
.set CG1_285, 46400
.set CG2_285, 46528
.set SG_285, 13789
.set CF_286, 48933
.set SF_286, 16196
.set CG1_286, 46397
.set CG2_286, 46525
.set SG_286, 13792
.set CF_287, 48930
.set SF_287, 16198
.set CG1_287, 46394
.set CG2_287, 46522
.set SG_287, 13794
.set CF_288, 48928
.set SF_288, 16200
.set CG1_288, 46390
.set CG2_288, 46518
.set SG_288, 13797
.set CF_289, 48925
.set SF_289, 16202
.set CG1_289, 46387
.set CG2_289, 46515
.set SG_289, 13799
.set CF_290, 48922
.set SF_290, 16205
.set CG1_290, 46384
.set CG2_290, 46512
.set SG_290, 13802
.set CF_291, 48919
.set SF_291, 16207
.set CG1_291, 46381
.set CG2_291, 46509
.set SG_291, 13804
.set CF_292, 48916
.set SF_292, 16209
.set CG1_292, 46377
.set CG2_292, 46505
.set SG_292, 13807
.set CF_293, 48913
.set SF_293, 16211
.set CG1_293, 46374
.set CG2_293, 46502
.set SG_293, 13809
.set CF_294, 48910
.set SF_294, 16213
.set CG1_294, 46371
.set CG2_294, 46499
.set SG_294, 13811
.set CF_295, 48907
.set SF_295, 16215
.set CG1_295, 46367
.set CG2_295, 46495
.set SG_295, 13814
.set CF_296, 48904
.set SF_296, 16217
.set CG1_296, 46364
.set CG2_296, 46492
.set SG_296, 13816
.set CF_297, 48901
.set SF_297, 16219
.set CG1_297, 46360
.set CG2_297, 46488
.set SG_297, 13818
.set CF_298, 48898
.set SF_298, 16220
.set CG1_298, 46357
.set CG2_298, 46485
.set SG_298, 13820
.set CF_299, 48894
.set SF_299, 16222
.set CG1_299, 46353
.set CG2_299, 46481
.set SG_299, 13822
.set CF_300, 48888
.set SF_300, 16224
.set CG1_300, 46350
.set CG2_300, 46478
.set SG_300, 13824
.set CF_301, 48881
.set SF_301, 16226
.set CG1_301, 46346
.set CG2_301, 46474
.set SG_301, 13825
.set CF_302, 48875
.set SF_302, 16227
.set CG1_302, 46342
.set CG2_302, 46470
.set SG_302, 13826
.set CF_303, 48869
.set SF_303, 16229
.set CG1_303, 46339
.set CG2_303, 46467
.set SG_303, 13827
.set CF_304, 48862
.set SF_304, 16231
.set CG1_304, 46334
.set CG2_304, 46462
.set SG_304, 13828
.set CF_305, 48856
.set SF_305, 16232
.set CG1_305, 46326
.set CG2_305, 46454
.set SG_305, 13829
.set CF_306, 48849
.set SF_306, 16234
.set CG1_306, 46319
.set CG2_306, 46447
.set SG_306, 13830
.set CF_307, 48843
.set SF_307, 16235
.set CG1_307, 46311
.set CG2_307, 46439
.set SG_307, 13830
.set CF_308, 48836
.set SF_308, 16237
.set CG1_308, 46304
.set CG2_308, 46432
.set SG_308, 13831
.set CF_309, 48829
.set SF_309, 16238
.set CG1_309, 46296
.set CG2_309, 46424
.set SG_309, 13832
.set CF_310, 48823
.set SF_310, 16239
.set CG1_310, 46289
.set CG2_310, 46417
.set SG_310, 13833
.set CF_311, 48816
.set SF_311, 16240
.set CG1_311, 46281
.set CG2_311, 46409
.set SG_311, 13833
.set CF_312, 48809
.set SF_312, 16242
.set CG1_312, 46273
.set CG2_312, 46401
.set SG_312, 13834
.set CF_313, 48802
.set SF_313, 16243
.set CG1_313, 46265
.set CG2_313, 46393
.set SG_313, 13835
.set CF_314, 48795
.set SF_314, 16244
.set CG1_314, 46258
.set CG2_314, 46386
.set SG_314, 13835
.set CF_315, 48789
.set SF_315, 16245
.set CG1_315, 46250
.set CG2_315, 46378
.set SG_315, 13836
.set CF_316, 48782
.set SF_316, 16246
.set CG1_316, 46242
.set CG2_316, 46370
.set SG_316, 13837
.set CF_317, 48775
.set SF_317, 16247
.set CG1_317, 46234
.set CG2_317, 46362
.set SG_317, 13837
.set CF_318, 48768
.set SF_318, 16248
.set CG1_318, 46226
.set CG2_318, 46354
.set SG_318, 13838
.set CF_319, 48754
.set SF_319, 16249
.set CG1_319, 46218
.set CG2_319, 46346
.set SG_319, 13838
.set CF_320, 48740
.set SF_320, 16250
.set CG1_320, 46210
.set CG2_320, 46338
.set SG_320, 13839
.set CF_321, 48726
.set SF_321, 16250
.set CG1_321, 46196
.set CG2_321, 46324
.set SG_321, 13839
.set CF_322, 48712
.set SF_322, 16251
.set CG1_322, 46180
.set CG2_322, 46308
.set SG_322, 13839
.set CF_323, 48698
.set SF_323, 16252
.set CG1_323, 46164
.set CG2_323, 46292
.set SG_323, 13840
.set CF_324, 48684
.set SF_324, 16252
.set CG1_324, 46148
.set CG2_324, 46276
.set SG_324, 13840
.set CF_325, 48669
.set SF_325, 16253
.set CG1_325, 46132
.set CG2_325, 46260
.set SG_325, 13841
.set CF_326, 48655
.set SF_326, 16253
.set CG1_326, 46116
.set CG2_326, 46244
.set SG_326, 13841
.set CF_327, 48641
.set SF_327, 16254
.set CG1_327, 46099
.set CG2_327, 46227
.set SG_327, 13841
.set CF_328, 48613
.set SF_328, 16254
.set CG1_328, 46083
.set CG2_328, 46211
.set SG_328, 13841
.set CF_329, 48585
.set SF_329, 16255
.set CG1_329, 46053
.set CG2_329, 46181
.set SG_329, 13842
.set CF_330, 48556
.set SF_330, 16255
.set CG1_330, 46021
.set CG2_330, 46149
.set SG_330, 13842
.set CF_331, 48527
.set SF_331, 16255
.set CG1_331, 45988
.set CG2_331, 46116
.set SG_331, 13842
.set CF_332, 48486
.set SF_332, 16256
.set CG1_332, 45955
.set CG2_332, 46083
.set SG_332, 13842
.set CF_333, 48428
.set SF_333, 16256
.set CG1_333, 45893
.set CG2_333, 46021
.set SG_333, 13842
.set CF_334, 48358
.set SF_334, 16256
.set CG1_334, 45827
.set CG2_334, 45955
.set SG_334, 13842
.set CF_335, 48230
.set SF_335, 16256
.set CG1_335, 45699
.set CG2_335, 45827
.set SG_335, 13842
.set CF_336, 0
.set SF_336, 16256
.set CG1_336, 0
.set CG2_336, 0
.set SG_336, 13842
.set CF_337, 15462
.set SF_337, 16256
.set CG1_337, 12931
.set CG2_337, 13059
.set SG_337, 13842
.set CF_338, 15590
.set SF_338, 16256
.set CG1_338, 13059
.set CG2_338, 13187
.set SG_338, 13842
.set CF_339, 15660
.set SF_339, 16256
.set CG1_339, 13125
.set CG2_339, 13253
.set SG_339, 13842
.set CF_340, 15718
.set SF_340, 16256
.set CG1_340, 13187
.set CG2_340, 13315
.set SG_340, 13842
.set CF_341, 15759
.set SF_341, 16255
.set CG1_341, 13220
.set CG2_341, 13348
.set SG_341, 13842
.set CF_342, 15788
.set SF_342, 16255
.set CG1_342, 13253
.set CG2_342, 13381
.set SG_342, 13842
.set CF_343, 15817
.set SF_343, 16255
.set CG1_343, 13285
.set CG2_343, 13413
.set SG_343, 13842
.set CF_344, 15845
.set SF_344, 16254
.set CG1_344, 13315
.set CG2_344, 13443
.set SG_344, 13841
.set CF_345, 15873
.set SF_345, 16254
.set CG1_345, 13331
.set CG2_345, 13459
.set SG_345, 13841
.set CF_346, 15887
.set SF_346, 16253
.set CG1_346, 13348
.set CG2_346, 13476
.set SG_346, 13841
.set CF_347, 15901
.set SF_347, 16253
.set CG1_347, 13364
.set CG2_347, 13492
.set SG_347, 13841
.set CF_348, 15916
.set SF_348, 16252
.set CG1_348, 13380
.set CG2_348, 13508
.set SG_348, 13840
.set CF_349, 15930
.set SF_349, 16252
.set CG1_349, 13396
.set CG2_349, 13524
.set SG_349, 13840
.set CF_350, 15944
.set SF_350, 16251
.set CG1_350, 13412
.set CG2_350, 13540
.set SG_350, 13839
.set CF_351, 15958
.set SF_351, 16250
.set CG1_351, 13428
.set CG2_351, 13556
.set SG_351, 13839
.set CF_352, 15972
.set SF_352, 16250
.set CG1_352, 13442
.set CG2_352, 13570
.set SG_352, 13839
.set CF_353, 15986
.set SF_353, 16249
.set CG1_353, 13450
.set CG2_353, 13578
.set SG_353, 13838
.set CF_354, 16000
.set SF_354, 16248
.set CG1_354, 13458
.set CG2_354, 13586
.set SG_354, 13838
.set CF_355, 16007
.set SF_355, 16247
.set CG1_355, 13466
.set CG2_355, 13594
.set SG_355, 13837
.set CF_356, 16014
.set SF_356, 16246
.set CG1_356, 13474
.set CG2_356, 13602
.set SG_356, 13837
.set CF_357, 16021
.set SF_357, 16245
.set CG1_357, 13482
.set CG2_357, 13610
.set SG_357, 13836
.set CF_358, 16027
.set SF_358, 16244
.set CG1_358, 13490
.set CG2_358, 13618
.set SG_358, 13835
.set CF_359, 16034
.set SF_359, 16243
.set CG1_359, 13497
.set CG2_359, 13625
.set SG_359, 13835
.set CF_360, 16041
.set SF_360, 16242
.set CG1_360, 13505
.set CG2_360, 13633
.set SG_360, 13834
.set CF_361, 16048
.set SF_361, 16240
.set CG1_361, 13513
.set CG2_361, 13641
.set SG_361, 13833
.set CF_362, 16055
.set SF_362, 16239
.set CG1_362, 13521
.set CG2_362, 13649
.set SG_362, 13833
.set CF_363, 16061
.set SF_363, 16238
.set CG1_363, 13528
.set CG2_363, 13656
.set SG_363, 13832
.set CF_364, 16068
.set SF_364, 16237
.set CG1_364, 13536
.set CG2_364, 13664
.set SG_364, 13831
.set CF_365, 16075
.set SF_365, 16235
.set CG1_365, 13543
.set CG2_365, 13671
.set SG_365, 13830
.set CF_366, 16081
.set SF_366, 16234
.set CG1_366, 13551
.set CG2_366, 13679
.set SG_366, 13830
.set CF_367, 16088
.set SF_367, 16232
.set CG1_367, 13558
.set CG2_367, 13686
.set SG_367, 13829
.set CF_368, 16094
.set SF_368, 16231
.set CG1_368, 13566
.set CG2_368, 13694
.set SG_368, 13828
.set CF_369, 16101
.set SF_369, 16229
.set CG1_369, 13571
.set CG2_369, 13699
.set SG_369, 13827
.set CF_370, 16107
.set SF_370, 16227
.set CG1_370, 13574
.set CG2_370, 13702
.set SG_370, 13826
.set CF_371, 16113
.set SF_371, 16226
.set CG1_371, 13578
.set CG2_371, 13706
.set SG_371, 13825
.set CF_372, 16120
.set SF_372, 16224
.set CG1_372, 13582
.set CG2_372, 13710
.set SG_372, 13824
.set CF_373, 16126
.set SF_373, 16222
.set CG1_373, 13585
.set CG2_373, 13713
.set SG_373, 13822
.set CF_374, 16130
.set SF_374, 16220
.set CG1_374, 13589
.set CG2_374, 13717
.set SG_374, 13820
.set CF_375, 16133
.set SF_375, 16219
.set CG1_375, 13592
.set CG2_375, 13720
.set SG_375, 13818
.set CF_376, 16136
.set SF_376, 16217
.set CG1_376, 13596
.set CG2_376, 13724
.set SG_376, 13816
.set CF_377, 16139
.set SF_377, 16215
.set CG1_377, 13599
.set CG2_377, 13727
.set SG_377, 13814
.set CF_378, 16142
.set SF_378, 16213
.set CG1_378, 13603
.set CG2_378, 13731
.set SG_378, 13811
.set CF_379, 16145
.set SF_379, 16211
.set CG1_379, 13606
.set CG2_379, 13734
.set SG_379, 13809
.set CF_380, 16148
.set SF_380, 16209
.set CG1_380, 13609
.set CG2_380, 13737
.set SG_380, 13807
.set CF_381, 16151
.set SF_381, 16207
.set CG1_381, 13613
.set CG2_381, 13741
.set SG_381, 13804
.set CF_382, 16154
.set SF_382, 16205
.set CG1_382, 13616
.set CG2_382, 13744
.set SG_382, 13802
.set CF_383, 16157
.set SF_383, 16202
.set CG1_383, 13619
.set CG2_383, 13747
.set SG_383, 13799
.set CF_384, 16160
.set SF_384, 16200
.set CG1_384, 13622
.set CG2_384, 13750
.set SG_384, 13797
.set CF_385, 16162
.set SF_385, 16198
.set CG1_385, 13626
.set CG2_385, 13754
.set SG_385, 13794
.set CF_386, 16165
.set SF_386, 16196
.set CG1_386, 13629
.set CG2_386, 13757
.set SG_386, 13792
.set CF_387, 16168
.set SF_387, 16193
.set CG1_387, 13632
.set CG2_387, 13760
.set SG_387, 13789
.set CF_388, 16171
.set SF_388, 16191
.set CG1_388, 13635
.set CG2_388, 13763
.set SG_388, 13786
.set CF_389, 16173
.set SF_389, 16188
.set CG1_389, 13638
.set CG2_389, 13766
.set SG_389, 13783
.set CF_390, 16176
.set SF_390, 16186
.set CG1_390, 13641
.set CG2_390, 13769
.set SG_390, 13781
.set CF_391, 16178
.set SF_391, 16184
.set CG1_391, 13644
.set CG2_391, 13772
.set SG_391, 13778
.set CF_392, 16181
.set SF_392, 16181
.set CG1_392, 13647
.set CG2_392, 13775
.set SG_392, 13775
.set CF_393, 16184
.set SF_393, 16178
.set CG1_393, 13650
.set CG2_393, 13778
.set SG_393, 13772
.set CF_394, 16186
.set SF_394, 16176
.set CG1_394, 13653
.set CG2_394, 13781
.set SG_394, 13769
.set CF_395, 16188
.set SF_395, 16173
.set CG1_395, 13655
.set CG2_395, 13783
.set SG_395, 13766
.set CF_396, 16191
.set SF_396, 16171
.set CG1_396, 13658
.set CG2_396, 13786
.set SG_396, 13763
.set CF_397, 16193
.set SF_397, 16168
.set CG1_397, 13661
.set CG2_397, 13789
.set SG_397, 13760
.set CF_398, 16196
.set SF_398, 16165
.set CG1_398, 13664
.set CG2_398, 13792
.set SG_398, 13757
.set CF_399, 16198
.set SF_399, 16162
.set CG1_399, 13666
.set CG2_399, 13794
.set SG_399, 13754
.set CF_400, 16200
.set SF_400, 16160
.set CG1_400, 13669
.set CG2_400, 13797
.set SG_400, 13750
.set CF_401, 16202
.set SF_401, 16157
.set CG1_401, 13671
.set CG2_401, 13799
.set SG_401, 13747
.set CF_402, 16205
.set SF_402, 16154
.set CG1_402, 13674
.set CG2_402, 13802
.set SG_402, 13744
.set CF_403, 16207
.set SF_403, 16151
.set CG1_403, 13676
.set CG2_403, 13804
.set SG_403, 13741
.set CF_404, 16209
.set SF_404, 16148
.set CG1_404, 13679
.set CG2_404, 13807
.set SG_404, 13737
.set CF_405, 16211
.set SF_405, 16145
.set CG1_405, 13681
.set CG2_405, 13809
.set SG_405, 13734
.set CF_406, 16213
.set SF_406, 16142
.set CG1_406, 13683
.set CG2_406, 13811
.set SG_406, 13731
.set CF_407, 16215
.set SF_407, 16139
.set CG1_407, 13686
.set CG2_407, 13814
.set SG_407, 13727
.set CF_408, 16217
.set SF_408, 16136
.set CG1_408, 13688
.set CG2_408, 13816
.set SG_408, 13724
.set CF_409, 16219
.set SF_409, 16133
.set CG1_409, 13690
.set CG2_409, 13818
.set SG_409, 13720
.set CF_410, 16220
.set SF_410, 16130
.set CG1_410, 13692
.set CG2_410, 13820
.set SG_410, 13717
.set CF_411, 16222
.set SF_411, 16126
.set CG1_411, 13694
.set CG2_411, 13822
.set SG_411, 13713
.set CF_412, 16224
.set SF_412, 16120
.set CG1_412, 13696
.set CG2_412, 13824
.set SG_412, 13710
.set CF_413, 16226
.set SF_413, 16113
.set CG1_413, 13697
.set CG2_413, 13825
.set SG_413, 13706
.set CF_414, 16227
.set SF_414, 16107
.set CG1_414, 13698
.set CG2_414, 13826
.set SG_414, 13702
.set CF_415, 16229
.set SF_415, 16101
.set CG1_415, 13699
.set CG2_415, 13827
.set SG_415, 13699
.set CF_416, 16231
.set SF_416, 16094
.set CG1_416, 13700
.set CG2_416, 13828
.set SG_416, 13694
.set CF_417, 16232
.set SF_417, 16088
.set CG1_417, 13701
.set CG2_417, 13829
.set SG_417, 13686
.set CF_418, 16234
.set SF_418, 16081
.set CG1_418, 13702
.set CG2_418, 13830
.set SG_418, 13679
.set CF_419, 16235
.set SF_419, 16075
.set CG1_419, 13702
.set CG2_419, 13830
.set SG_419, 13671
.set CF_420, 16237
.set SF_420, 16068
.set CG1_420, 13703
.set CG2_420, 13831
.set SG_420, 13664
.set CF_421, 16238
.set SF_421, 16061
.set CG1_421, 13704
.set CG2_421, 13832
.set SG_421, 13656
.set CF_422, 16239
.set SF_422, 16055
.set CG1_422, 13705
.set CG2_422, 13833
.set SG_422, 13649
.set CF_423, 16240
.set SF_423, 16048
.set CG1_423, 13705
.set CG2_423, 13833
.set SG_423, 13641
.set CF_424, 16242
.set SF_424, 16041
.set CG1_424, 13706
.set CG2_424, 13834
.set SG_424, 13633
.set CF_425, 16243
.set SF_425, 16034
.set CG1_425, 13707
.set CG2_425, 13835
.set SG_425, 13625
.set CF_426, 16244
.set SF_426, 16027
.set CG1_426, 13707
.set CG2_426, 13835
.set SG_426, 13618
.set CF_427, 16245
.set SF_427, 16021
.set CG1_427, 13708
.set CG2_427, 13836
.set SG_427, 13610
.set CF_428, 16246
.set SF_428, 16014
.set CG1_428, 13709
.set CG2_428, 13837
.set SG_428, 13602
.set CF_429, 16247
.set SF_429, 16007
.set CG1_429, 13709
.set CG2_429, 13837
.set SG_429, 13594
.set CF_430, 16248
.set SF_430, 16000
.set CG1_430, 13710
.set CG2_430, 13838
.set SG_430, 13586
.set CF_431, 16249
.set SF_431, 15986
.set CG1_431, 13710
.set CG2_431, 13838
.set SG_431, 13578
.set CF_432, 16250
.set SF_432, 15972
.set CG1_432, 13711
.set CG2_432, 13839
.set SG_432, 13570
.set CF_433, 16250
.set SF_433, 15958
.set CG1_433, 13711
.set CG2_433, 13839
.set SG_433, 13556
.set CF_434, 16251
.set SF_434, 15944
.set CG1_434, 13711
.set CG2_434, 13839
.set SG_434, 13540
.set CF_435, 16252
.set SF_435, 15930
.set CG1_435, 13712
.set CG2_435, 13840
.set SG_435, 13524
.set CF_436, 16252
.set SF_436, 15916
.set CG1_436, 13712
.set CG2_436, 13840
.set SG_436, 13508
.set CF_437, 16253
.set SF_437, 15901
.set CG1_437, 13713
.set CG2_437, 13841
.set SG_437, 13492
.set CF_438, 16253
.set SF_438, 15887
.set CG1_438, 13713
.set CG2_438, 13841
.set SG_438, 13476
.set CF_439, 16254
.set SF_439, 15873
.set CG1_439, 13713
.set CG2_439, 13841
.set SG_439, 13459
.set CF_440, 16254
.set SF_440, 15845
.set CG1_440, 13713
.set CG2_440, 13841
.set SG_440, 13443
.set CF_441, 16255
.set SF_441, 15817
.set CG1_441, 13714
.set CG2_441, 13842
.set SG_441, 13413
.set CF_442, 16255
.set SF_442, 15788
.set CG1_442, 13714
.set CG2_442, 13842
.set SG_442, 13381
.set CF_443, 16255
.set SF_443, 15759
.set CG1_443, 13714
.set CG2_443, 13842
.set SG_443, 13348
.set CF_444, 16256
.set SF_444, 15718
.set CG1_444, 13714
.set CG2_444, 13842
.set SG_444, 13315
.set CF_445, 16256
.set SF_445, 15660
.set CG1_445, 13714
.set CG2_445, 13842
.set SG_445, 13253
.set CF_446, 16256
.set SF_446, 15590
.set CG1_446, 13714
.set CG2_446, 13842
.set SG_446, 13187
.set CF_447, 16256
.set SF_447, 15462
.set CG1_447, 13714
.set CG2_447, 13842
.set SG_447, 13059
.macro emCF idx
  .short CF_\idx
.endm
.macro emSF idx
  .short SF_\idx
.endm
.macro emCG1 idx
  .short CG1_\idx
.endm
.macro emCG2 idx
  .short CG2_\idx
.endm
.macro emSG idx
  .short SG_\idx
.endm
.section .rodata,"a"
.p2align 8
.type tblF,@object
tblF:
.set td, 0
.rept 448
  .set tc, 0
  .rept 225
    emCF %((td*tc)%448)
    .set tc, tc+1
  .endr
  .set tc, 1
  .rept 223
    emSF %((td*tc)%448)
    .set tc, tc+1
  .endr
  .fill 64, 2, 0
  .set td, td+1
.endr
.p2align 8
.type tblG,@object
tblG:
.set td, 0
.rept 448
  emCG1 0
.endr
.set tc, 1
.rept 223
  .set td, 0
  .rept 448
    emCG2 %((td*tc)%448)
    .set td, td+1
  .endr
  .set tc, tc+1
.endr
.set td, 0
.rept 448
  emCG1 %((td*224)%448)
  .set td, td+1
.endr
.set tc, 1
.rept 223
  .set td, 0
  .rept 448
    emSG %((td*tc)%448)
    .set td, td+1
  .endr
  .set tc, tc+1
.endr
.p2align 8
.type tblTW,@object
tblTW:
  .long 0x3f800000, 0x80000000, 0x3f7fffb1, 0xbb490fc6, 0x3f7ffec4, 0xbbc90f88, 0x3f7ffd39, 0xbc16cb58
  .long 0x3f7ffb11, 0xbc490e90, 0x3f7ff84a, 0xbc7b514b, 0x3f7ff4e6, 0xbc96c9b6, 0x3f7ff0e3, 0xbcafea69
  .long 0x3f7fec43, 0xbcc90ab0, 0x3f7fe705, 0xbce22a7a, 0x3f7fe129, 0xbcfb49ba, 0x3f7fdaaf, 0xbd0a342f
  .long 0x3f7fd397, 0xbd16c32c, 0x3f7fcbe2, 0xbd2351cb, 0x3f7fc38f, 0xbd2fe007, 0x3f7fba9e, 0xbd3c6dd5
  .long 0x3f7fb10f, 0xbd48fb30, 0x3f7fa6e3, 0xbd55880e, 0x3f7f9c18, 0xbd621469, 0x3f7f90b1, 0xbd6ea038
  .long 0x3f7f84ab, 0xbd7b2b74, 0x3f7f7808, 0xbd83db0a, 0x3f7f6ac7, 0xbd8a200a, 0x3f7f5ce9, 0xbd9064b4
  .long 0x3f7f4e6d, 0xbd96a905, 0x3f7f3f54, 0xbd9cecf9, 0x3f7f2f9d, 0xbda3308c, 0x3f7f1f49, 0xbda973ba
  .long 0x3f7f0e58, 0xbdafb680, 0x3f7efcc9, 0xbdb5f8da, 0x3f7eea9d, 0xbdbc3ac3, 0x3f7ed7d4, 0xbdc27c39
  .long 0x3f7ec46d, 0xbdc8bd36, 0x3f7eb069, 0xbdcefdb7, 0x3f7e9bc9, 0xbdd53db9, 0x3f7e868b, 0xbddb7d37
  .long 0x3f7e70b0, 0xbde1bc2e, 0x3f7e5a38, 0xbde7fa9a, 0x3f7e4323, 0xbdee3876, 0x3f7e2b72, 0xbdf475c0
  .long 0x3f7e1324, 0xbdfab273, 0x3f7dfa38, 0xbe007745, 0x3f7de0b1, 0xbe039502, 0x3f7dc68c, 0xbe06b26e
  .long 0x3f7dabcc, 0xbe09cf86, 0x3f7d906e, 0xbe0cec4a, 0x3f7d7474, 0xbe1008b7, 0x3f7d57de, 0xbe1324ca
  .long 0x3f7d3aac, 0xbe164083, 0x3f7d1cdd, 0xbe195be0, 0x3f7cfe73, 0xbe1c76de, 0x3f7cdf6c, 0xbe1f917b
  .long 0x3f7cbfc9, 0xbe22abb6, 0x3f7c9f8a, 0xbe25c58c, 0x3f7c7eb0, 0xbe28defc, 0x3f7c5d3a, 0xbe2bf804
  .long 0x3f7c3b28, 0xbe2f10a2, 0x3f7c187a, 0xbe3228d4, 0x3f7bf531, 0xbe354098, 0x3f7bd14d, 0xbe3857ec
  .long 0x3f7baccd, 0xbe3b6ecf, 0x3f7b87b2, 0xbe3e853e, 0x3f7b61fc, 0xbe419b37, 0x3f7b3bab, 0xbe44b0b9
  .long 0x3f7b14be, 0xbe47c5c2, 0x3f7aed37, 0xbe4ada4f, 0x3f7ac516, 0xbe4dee60, 0x3f7a9c59, 0xbe5101f1
  .long 0x3f7a7302, 0xbe541501, 0x3f7a4910, 0xbe57278f, 0x3f7a1e84, 0xbe5a3997, 0x3f79f35e, 0xbe5d4b1a
  .long 0x3f79c79d, 0xbe605c13, 0x3f799b43, 0xbe636c83, 0x3f796e4e, 0xbe667c66, 0x3f7940c0, 0xbe698bba
  .long 0x3f791298, 0xbe6c9a7f, 0x3f78e3d6, 0xbe6fa8b2, 0x3f78b47b, 0xbe72b651, 0x3f788486, 0xbe75c35a
  .long 0x3f7853f8, 0xbe78cfcc, 0x3f7822d1, 0xbe7bdba4, 0x3f77f110, 0xbe7ee6e1, 0x3f77beb7, 0xbe80f8c0
  .long 0x3f778bc5, 0xbe827dc0, 0x3f77583a, 0xbe840270, 0x3f772417, 0xbe8586ce, 0x3f76ef5b, 0xbe870ada
  .long 0x3f76ba07, 0xbe888e93, 0x3f76841b, 0xbe8a11f7, 0x3f764d97, 0xbe8b9507, 0x3f76167a, 0xbe8d17c0
  .long 0x3f75dec6, 0xbe8e9a22, 0x3f75a67b, 0xbe901c2c, 0x3f756d97, 0xbe919ddd, 0x3f75341d, 0xbe931f35
  .long 0x3f74fa0b, 0xbe94a031, 0x3f74bf62, 0xbe9620d2, 0x3f748422, 0xbe97a117, 0x3f74484b, 0xbe9920fe
  .long 0x3f740bdd, 0xbe9aa086, 0x3f73ced9, 0xbe9c1faf, 0x3f73913f, 0xbe9d9e78, 0x3f73530e, 0xbe9f1cdf
  .long 0x3f731447, 0xbea09ae5, 0x3f72d4eb, 0xbea21887, 0x3f7294f8, 0xbea395c5, 0x3f725470, 0xbea5129f
  .long 0x3f721352, 0xbea68f12, 0x3f71d19f, 0xbea80b1f, 0x3f718f57, 0xbea986c4, 0x3f714c7a, 0xbeab0201
  .long 0x3f710908, 0xbeac7cd4, 0x3f70c501, 0xbeadf73c, 0x3f708066, 0xbeaf713a, 0x3f703b37, 0xbeb0eacb
  .long 0x3f6ff573, 0xbeb263ef, 0x3f6faf1b, 0xbeb3dca5, 0x3f6f6830, 0xbeb554ec, 0x3f6f20b0, 0xbeb6ccc3
  .long 0x3f6ed89e, 0xbeb8442a, 0x3f6e8ff8, 0xbeb9bb1e, 0x3f6e46be, 0xbebb31a0, 0x3f6dfcf2, 0xbebca7af
  .long 0x3f6db293, 0xbebe1d4a, 0x3f6d67a1, 0xbebf926f, 0x3f6d1c1d, 0xbec1071e, 0x3f6cd007, 0xbec27b55
  .long 0x3f6c835e, 0xbec3ef15, 0x3f6c3624, 0xbec5625c, 0x3f6be858, 0xbec6d529, 0x3f6b99fb, 0xbec8477c
  .long 0x3f6b4b0c, 0xbec9b953, 0x3f6afb8c, 0xbecb2aae, 0x3f6aab7b, 0xbecc9b8b, 0x3f6a5ad9, 0xbece0bea
  .long 0x3f6a09a7, 0xbecf7bca, 0x3f69b7e4, 0xbed0eb2a, 0x3f696591, 0xbed25a09, 0x3f6912ae, 0xbed3c867
  .long 0x3f68bf3c, 0xbed53641, 0x3f686b39, 0xbed6a399, 0x3f6816a8, 0xbed8106b, 0x3f67c187, 0xbed97cb9
  .long 0x3f676bd8, 0xbedae880, 0x3f671599, 0xbedc53c1, 0x3f66becc, 0xbeddbe79, 0x3f666771, 0xbedf28a9
  .long 0x3f660f88, 0xbee0924f, 0x3f65b710, 0xbee1fb6a, 0x3f655e0b, 0xbee363fa, 0x3f650479, 0xbee4cbfe
  .long 0x3f64aa59, 0xbee63375, 0x3f644fac, 0xbee79a5d, 0x3f63f473, 0xbee900b7, 0x3f6398ac, 0xbeea6681
  .long 0x3f633c5a, 0xbeebcbbb, 0x3f62df7b, 0xbeed3063, 0x3f628210, 0xbeee9479, 0x3f62241a, 0xbeeff7fb
  .long 0x3f61c598, 0xbef15aea, 0x3f61668a, 0xbef2bd43, 0x3f6106f2, 0xbef41f07, 0x3f60a6cf, 0xbef58035
  .long 0x3f604621, 0xbef6e0cb, 0x3f5fe4e9, 0xbef840c8, 0x3f5f8327, 0xbef9a02d, 0x3f5f20db, 0xbefafef7
  .long 0x3f5ebe05, 0xbefc5d27, 0x3f5e5aa6, 0xbefdbabb, 0x3f5df6be, 0xbeff17b2, 0x3f5d924d, 0xbf003a06
  .long 0x3f5d2d53, 0xbf00e7e4, 0x3f5cc7d1, 0xbf019573, 0x3f5c61c7, 0xbf0242b1, 0x3f5bfb34, 0xbf02ef9f
  .long 0x3f5b941a, 0xbf039c3d, 0x3f5b2c79, 0xbf044889, 0x3f5ac450, 0xbf04f484, 0x3f5a5ba0, 0xbf05a02c
  .long 0x3f59f26a, 0xbf064b82, 0x3f5988ad, 0xbf06f686, 0x3f591e6a, 0xbf07a136, 0x3f58b3a1, 0xbf084b92
  .long 0x3f584853, 0xbf08f59b, 0x3f57dc7f, 0xbf099f4e, 0x3f577026, 0xbf0a48ad, 0x3f570348, 0xbf0af1b7
  .long 0x3f5695e5, 0xbf0b9a6b, 0x3f5627fe, 0xbf0c42c9, 0x3f55b993, 0xbf0cead0, 0x3f554aa4, 0xbf0d9281
  .long 0x3f54db31, 0xbf0e39da, 0x3f546b3b, 0xbf0ee0db, 0x3f53fac3, 0xbf0f8784, 0x3f5389c7, 0xbf102dd5
  .long 0x3f531849, 0xbf10d3cd, 0x3f52a649, 0xbf11796b, 0x3f5233c6, 0xbf121eb0, 0x3f51c0c2, 0xbf12c39a
  .long 0x3f514d3d, 0xbf13682a, 0x3f50d937, 0xbf140c5f, 0x3f5064af, 0xbf14b039, 0x3f4fefa8, 0xbf1553b7
  .long 0x3f4f7a1f, 0xbf15f6d9, 0x3f4f0417, 0xbf16999f, 0x3f4e8d90, 0xbf173c07, 0x3f4e1689, 0xbf17de12
  .long 0x3f4d9f02, 0xbf187fc0, 0x3f4d26fd, 0xbf19210f, 0x3f4cae79, 0xbf19c200, 0x3f4c3578, 0xbf1a6293
  .long 0x3f4bbbf8, 0xbf1b02c6, 0x3f4b41fa, 0xbf1ba299, 0x3f4ac77f, 0xbf1c420c, 0x3f4a4c87, 0xbf1ce11f
  .long 0x3f49d112, 0xbf1d7fd1, 0x3f495521, 0xbf1e1e22, 0x3f48d8b3, 0xbf1ebc12, 0x3f485bca, 0xbf1f599f
  .long 0x3f47de65, 0xbf1ff6cb, 0x3f476085, 0xbf209393, 0x3f46e22a, 0xbf212ff9, 0x3f466354, 0xbf21cbfb
  .long 0x3f45e403, 0xbf226799, 0x3f456439, 0xbf2302d3, 0x3f44e3f5, 0xbf239da9, 0x3f446337, 0xbf24381a
  .long 0x3f43e200, 0xbf24d225, 0x3f436051, 0xbf256bcb, 0x3f42de29, 0xbf26050a, 0x3f425b89, 0xbf269de3
  .long 0x3f41d870, 0xbf273656, 0x3f4154e1, 0xbf27ce61, 0x3f40d0da, 0xbf286605, 0x3f404c5c, 0xbf28fd41
  .long 0x3f3fc767, 0xbf299415, 0x3f3f41fc, 0xbf2a2a80, 0x3f3ebc1b, 0xbf2ac082, 0x3f3e35c5, 0xbf2b561b
  .long 0x3f3daef9, 0xbf2beb4a, 0x3f3d27b8, 0xbf2c800f, 0x3f3ca003, 0xbf2d1469, 0x3f3c17d9, 0xbf2da859
  .long 0x3f3b8f3b, 0xbf2e3bde, 0x3f3b0629, 0xbf2ecef7, 0x3f3a7ca4, 0xbf2f61a5, 0x3f39f2ac, 0xbf2ff3e6
  .long 0x3f396842, 0xbf3085bb, 0x3f38dd65, 0xbf311722, 0x3f385216, 0xbf31a81d, 0x3f37c655, 0xbf3238aa
  .long 0x3f373a23, 0xbf32c8c9, 0x3f36ad7f, 0xbf33587a, 0x3f36206c, 0xbf33e7bc, 0x3f3592e7, 0xbf34768f
  .long 0x3f800000, 0x80000000, 0x3f7fec43, 0xbcc90ab0, 0x3f7fb10f, 0xbd48fb30, 0x3f7f4e6d, 0xbd96a905
  .long 0x3f7ec46d, 0xbdc8bd36, 0x3f7e1324, 0xbdfab273, 0x3f7d3aac, 0xbe164083, 0x3f7c3b28, 0xbe2f10a2
  .long 0x3f7b14be, 0xbe47c5c2, 0x3f79c79d, 0xbe605c13, 0x3f7853f8, 0xbe78cfcc, 0x3f76ba07, 0xbe888e93
  .long 0x3f74fa0b, 0xbe94a031, 0x3f731447, 0xbea09ae5, 0x3f710908, 0xbeac7cd4, 0x3f6ed89e, 0xbeb8442a
  .long 0x3f6c835e, 0xbec3ef15, 0x3f6a09a7, 0xbecf7bca, 0x3f676bd8, 0xbedae880, 0x3f64aa59, 0xbee63375
  .long 0x3f61c598, 0xbef15aea, 0x3f5ebe05, 0xbefc5d27, 0x3f5b941a, 0xbf039c3d, 0x3f584853, 0xbf08f59b
  .long 0x3f54db31, 0xbf0e39da, 0x3f514d3d, 0xbf13682a, 0x3f4d9f02, 0xbf187fc0, 0x3f49d112, 0xbf1d7fd1
  .long 0x3f45e403, 0xbf226799, 0x3f41d870, 0xbf273656, 0x3f3daef9, 0xbf2beb4a, 0x3f396842, 0xbf3085bb
  .long 0x3f800000, 0x80000000, 0x3f7b14be, 0xbe47c5c2, 0x3f6c835e, 0xbec3ef15, 0x3f54db31, 0xbf0e39da
```
